```python
import torch

def _softmax(x, axis=-1):
    return torch.softmax(x, dim=axis)

def _gelu(x):
    return torch.nn.functional.gelu(x, approximate='tanh')

def _silu(x):
    return torch.nn.functional.silu(x)

def _sigmoid(x):
    return torch.sigmoid(x)

def _layernorm(x, axis=-1, eps=1e-05):
    m = x.mean(dim=axis, keepdim=True)
    v = x.var(dim=axis, keepdim=True, unbiased=False)
    return (x - m) / torch.sqrt(v + eps)

def _scatter_add(tgt, idx, src, axis=0):
    return tgt.clone().index_add_(axis, idx, src)

def _segment_sum(src, seg, n):
    out = torch.zeros((n,) + src.shape[1:], dtype=src.dtype)
    return out.index_add_(0, seg, src)

def _pad(x, pw):
    flat = tuple((v for pair in reversed(pw) for v in pair))
    return torch.nn.functional.pad(x, flat)
kernel_name = 'adaLN_cond__mha_block_cached__glu_gated_glu__decode'

def setup_inputs():

    _w = lambda a: (lambda t: t.to(torch.bfloat16) if t.is_floating_point() else t)(torch.as_tensor(a))

    def _A_setup():
        B, Sq, D = (2, 1, 448)
        H, Sk, Dh = (16, 8192, 256)
        return {'x': _w((lambda *s: torch.randn(*s, dtype=torch.bfloat16) * 0.05)(B, Sq, D)), 'k_cache': _w((lambda *s: torch.randn(*s, dtype=torch.bfloat16) * 3.2)(B, H, Sk, Dh)), 'v_cache': _w((lambda *s: torch.randn(*s, dtype=torch.bfloat16) * 0.4)(B, H, Sk, Dh)), 'wq': _w((lambda *s: torch.randn(*s, dtype=torch.bfloat16) * 3.2)(D, H * Dh) * D ** (-0.5)), 'wo': _w((lambda *s: torch.randn(*s, dtype=torch.bfloat16) * 0.4)(H * Dh, D) * (H * Dh) ** (-0.5))}
    _A_in = _A_setup()

    def _B_setup():
        B, S, D, F = (2, 1, 448, 1792)
        return {'x': _w((lambda *s: torch.randn(*s, dtype=torch.bfloat16) * 0.05)(B, S, D)), 'w_gate': _w((lambda *s: torch.randn(*s, dtype=torch.bfloat16) * 0.05)(D, F)), 'w_up': _w((lambda *s: torch.randn(*s, dtype=torch.bfloat16) * 0.05)(D, F)), 'w_down': _w((lambda *s: torch.randn(*s, dtype=torch.bfloat16) * 0.05)(F, D))}
    _B_in = _B_setup()
    return {'A_x': _A_in['x'], 'A_k_cache': _A_in['k_cache'], 'A_v_cache': _A_in['v_cache'], 'A_wq': _A_in['wq'], 'A_wo': _A_in['wo'], 'B_x': _B_in['x'], 'B_w_gate': _B_in['w_gate'], 'B_w_up': _B_in['w_up'], 'B_w_down': _B_in['w_down'], 'c': _w((lambda *s: torch.randn(*s, dtype=torch.bfloat16) * 0.1)(2, 448) * 8.0), 'w_mod': _w((lambda *s: torch.randn(*s, dtype=torch.bfloat16) * 0.1)(448, 6 * 448) * 448 ** (-0.5) * 8.0)}

def reference(A_x, A_k_cache, A_v_cache, A_wq, A_wo, B_x, B_w_gate, B_w_up, B_w_down, c, w_mod):

    def _A_ref(x, k_cache, v_cache, wq, wo):
        B, Sq, D = x.shape
        H, Dh = (16, 256)
        q = (lambda x, *d: x.permute(*d))((x @ wq).reshape(B, Sq, H, Dh), 0, 2, 1, 3)
        scores = torch.einsum('bhqd,bhkd->bhqk', q, k_cache) * Dh ** (-0.5)
        p = _softmax(scores, axis=-1)
        o = torch.einsum('bhqk,bhkd->bhqd', p, v_cache)
        return (lambda x, *d: x.permute(*d))(o, 0, 2, 1, 3).reshape(B, Sq, H * Dh) @ wo

    def _B_ref(x, w_gate, w_up, w_down):
        g = torch.einsum('bsd,df->bsf', x, w_gate)
        u = torch.einsum('bsd,df->bsf', x, w_up)
        h = _sigmoid(g) * u
        return torch.einsum('bsf,fd->bsd', h, w_down)
    x = A_x
    mod = (_silu(c) @ w_mod).reshape(c.shape[0], 6, 1, -1)
    sa, ca, ga, sb, cb, gb = (mod[:, 0].clone(), mod[:, 1].clone(), mod[:, 2].clone(), mod[:, 3].clone(), mod[:, 4].clone(), mod[:, 5].clone())
    h = _layernorm(x, axis=-1) * (1 + ca) + sa
    x = x + ga * _A_ref(h, A_k_cache, A_v_cache, A_wq, A_wo)
    h = _layernorm(x, axis=-1) * (1 + cb) + sb
    x = x + gb * _B_ref(h, B_w_gate, B_w_up, B_w_down)
    return x
```

```asm
; @launch grid=(256,1,1) block=(512,1,1) lds=157696
.amdgcn_target "amdgcn-amd-amdhsa--gfx950"
.text
.globl adaLN_cond__mha_block_cached__glu_gated_glu__decode_kernel
.p2align 8
.type adaLN_cond__mha_block_cached__glu_gated_glu__decode_kernel,@function
adaLN_cond__mha_block_cached__glu_gated_glu__decode_kernel:
s_cmp_ge_u32 s2, 256
s_cbranch_scc1 L_end
s_load_dwordx16 s[8:23], s[0:1], 0
s_load_dwordx8 s[24:31], s[0:1], 64
s_load_dwordx4 s[32:35], s[0:1], 96
v_lshrrev_b32 v1, 6, v0
v_and_b32 v0, 63, v0
v_readfirstlane_b32 s37, v1
s_lshr_b32 s38, s2, 3
s_and_b32 s39, s2, 7
s_lshr_b32 s40, s38, 4
s_and_b32 s41, s38, 15
s_mov_b32 s65, 0x3db8aa3b
s_cmp_ge_u32 s37, 4
s_cbranch_scc1 L_service
s_mov_b32 s42, s37
s_mov_b32 s66, 0x131d181d
s_mov_b32 s67, 0x151d161b
s_mov_b32 s68, 0x52351d00
s_mov_b32 s69, 0xb3968065
s_cmp_lt_u32 s38, 28
s_cselect_b32 s66, s66, 0x121c1b1c
s_cselect_b32 s67, s67, 0x131c1a1a
s_cselect_b32 s68, s68, 0x53371c00
s_cselect_b32 s69, s69, 0xb5997f65
s_lshl_b32 s70, s39, 3
s_lshr_b64 s[66:67], s[66:67], s70
s_lshr_b64 s[68:69], s[68:69], s70
s_and_b32 s86, s66, 0xff
s_and_b32 s68, s68, 0xff
s_lshl_b32 s68, s68, 14
s_mov_b32 s57, s86
s_mov_b32 s86, 255
s_mov_b32 s58, 0
s_mov_b32 s81, s68
s_lshl_b32 s68, s38, 22
s_mov_b32 s46, 4194304
s_mov_b32 s47, 0x20000
s_mov_b32 s50, s46
s_mov_b32 s51, 0x20000
v_lshrrev_b32 v56, 4, v0
v_bfe_u32 v57, v0, 2, 2
v_and_b32 v58, 3, v0
v_and_b32 v59, 15, v0
s_lshl_b32 s70, s42, 12
v_lshlrev_b32 v60, 6, v56
v_lshlrev_b32 v61, 9, v57
v_lshlrev_b32 v62, 4, v58
v_add3_u32 v1, v60, v61, v62
v_add_u32 v1, s70, v1
v_lshlrev_b32 v60, 9, v56
v_lshlrev_b32 v61, 4, v59
v_add3_u32 v2, v60, v61, s70
v_mov_b32 v3, v1
v_mov_b32 v53, v2
v_add_u32 v1, s81, v1
v_add_u32 v2, s81, v2
v_and_b32 v60, 1, v59
v_cmp_eq_u32 vcc, 1, v60
v_mov_b32 v61, 0xffff
v_mov_b32 v62, 0xffff0000
v_cndmask_b32 v61, v61, v62, vcc
v_bfe_u32 v60, v59, 1, 2
v_cmp_eq_u32 vcc, 0, v60
s_nop 1
v_cndmask_b32 v12, 0, v61, vcc
v_cmp_eq_u32 vcc, 1, v60
s_nop 1
v_cndmask_b32 v13, 0, v61, vcc
v_cmp_eq_u32 vcc, 2, v60
s_nop 1
v_cndmask_b32 v14, 0, v61, vcc
v_cmp_eq_u32 vcc, 3, v60
s_nop 1
v_cndmask_b32 v15, 0, v61, vcc
v_lshlrev_b32 v50, 6, v56
v_lshlrev_b32 v60, 4, v58
v_add_u32 v50, v50, v60
v_lshlrev_b32 v51, 7, v56
v_and_b32 v60, 7, v59
v_lshlrev_b32 v60, 2, v60
s_lshl_b32 s70, s42, 10
v_add3_u32 v51, v51, v60, s70
s_mul_i32 s71, s42, 16384
v_lshlrev_b32 v52, 4, v0
v_add_u32 v52, s71, v52
s_add_u32 s71, s71, 18432
s_waitcnt lgkmcnt(0)
s_add_u32 s44, s10, s68
s_addc_u32 s45, s11, 0
s_add_u32 s48, s12, s68
s_addc_u32 s49, s13, 0
s_cmp_eq_u32 s39, 3
s_cbranch_scc1 L_pwg
s_cmp_eq_u32 s39, 7
s_cbranch_scc1 L_pwg
s_cmp_lt_u32 s38, 14
s_cselect_b32 s70, 6, 8
s_cmp_eq_u32 s39, s70
s_cbranch_scc1 L_pwg
buffer_load_dwordx4 v[56:59], v1, s[44:47], 0 offen offset:0 nt
buffer_load_dwordx4 v[60:63], v1, s[44:47], 0 offen offset:256 nt
buffer_load_dwordx4 v[64:67], v1, s[44:47], 0 offen offset:2048 nt
buffer_load_dwordx4 v[68:71], v1, s[44:47], 0 offen offset:2304 nt
v_add_u32 v1, 0x4000, v1
buffer_load_dwordx4 v[72:75], v2, s[48:51], 0 offen offset:0 nt
buffer_load_dwordx4 v[76:79], v2, s[48:51], 0 offen offset:256 nt
buffer_load_dwordx4 v[80:83], v2, s[48:51], 0 offen offset:2048 nt
buffer_load_dwordx4 v[84:87], v2, s[48:51], 0 offen offset:2304 nt
v_add_u32 v2, 0x4000, v2
s_barrier
v_mov_b32 v16, 0
v_mov_b32 v17, 0
v_mov_b32 v18, 0
v_mov_b32 v19, 0
v_mov_b32 v20, 0
v_mov_b32 v21, 0
v_mov_b32 v22, 0
v_mov_b32 v23, 0
v_mov_b32 v40, 0xff61b1e6
v_mov_b32 v41, 0
buffer_load_dwordx4 v[88:91], v1, s[44:47], 0 offen offset:0 nt
buffer_load_dwordx4 v[92:95], v1, s[44:47], 0 offen offset:256 nt
buffer_load_dwordx4 v[96:99], v1, s[44:47], 0 offen offset:2048 nt
buffer_load_dwordx4 v[100:103], v1, s[44:47], 0 offen offset:2304 nt
v_add_u32 v1, 0x4000, v1
buffer_load_dwordx4 v[104:107], v2, s[48:51], 0 offen offset:0 nt
buffer_load_dwordx4 v[108:111], v2, s[48:51], 0 offen offset:256 nt
buffer_load_dwordx4 v[112:115], v2, s[48:51], 0 offen offset:2048 nt
buffer_load_dwordx4 v[116:119], v2, s[48:51], 0 offen offset:2304 nt
v_add_u32 v2, 0x4000, v2
buffer_load_dwordx4 v[120:123], v1, s[44:47], 0 offen offset:0 nt
buffer_load_dwordx4 v[124:127], v1, s[44:47], 0 offen offset:256 nt
buffer_load_dwordx4 v[128:131], v1, s[44:47], 0 offen offset:2048 nt
buffer_load_dwordx4 v[132:135], v1, s[44:47], 0 offen offset:2304 nt
v_add_u32 v1, 0x4000, v1
buffer_load_dwordx4 v[136:139], v2, s[48:51], 0 offen offset:0 nt
buffer_load_dwordx4 v[140:143], v2, s[48:51], 0 offen offset:256 nt
buffer_load_dwordx4 v[144:147], v2, s[48:51], 0 offen offset:2048 nt
buffer_load_dwordx4 v[148:151], v2, s[48:51], 0 offen offset:2304 nt
v_add_u32 v2, 0x4000, v2
buffer_load_dwordx4 v[152:155], v1, s[44:47], 0 offen offset:0 nt
buffer_load_dwordx4 v[156:159], v1, s[44:47], 0 offen offset:256 nt
buffer_load_dwordx4 v[160:163], v1, s[44:47], 0 offen offset:2048 nt
buffer_load_dwordx4 v[164:167], v1, s[44:47], 0 offen offset:2304 nt
v_add_u32 v1, 0x4000, v1
buffer_load_dwordx4 v[168:171], v2, s[48:51], 0 offen offset:0 nt
buffer_load_dwordx4 v[172:175], v2, s[48:51], 0 offen offset:256 nt
buffer_load_dwordx4 v[176:179], v2, s[48:51], 0 offen offset:2048 nt
buffer_load_dwordx4 v[180:183], v2, s[48:51], 0 offen offset:2304 nt
v_add_u32 v2, 0x4000, v2
buffer_load_dwordx4 v[184:187], v1, s[44:47], 0 offen offset:0 nt
buffer_load_dwordx4 v[188:191], v1, s[44:47], 0 offen offset:256 nt
buffer_load_dwordx4 v[192:195], v1, s[44:47], 0 offen offset:2048 nt
buffer_load_dwordx4 v[196:199], v1, s[44:47], 0 offen offset:2304 nt
v_add_u32 v1, 0x4000, v1
buffer_load_dwordx4 v[200:203], v2, s[48:51], 0 offen offset:0 nt
buffer_load_dwordx4 v[204:207], v2, s[48:51], 0 offen offset:256 nt
buffer_load_dwordx4 v[208:211], v2, s[48:51], 0 offen offset:2048 nt
buffer_load_dwordx4 v[212:215], v2, s[48:51], 0 offen offset:2304 nt
v_add_u32 v2, 0x4000, v2
buffer_load_dwordx4 v[216:219], v1, s[44:47], 0 offen offset:0 nt
buffer_load_dwordx4 v[220:223], v1, s[44:47], 0 offen offset:256 nt
buffer_load_dwordx4 v[224:227], v1, s[44:47], 0 offen offset:2048 nt
buffer_load_dwordx4 v[228:231], v1, s[44:47], 0 offen offset:2304 nt
v_add_u32 v1, 0x4000, v1
buffer_load_dwordx4 v[232:235], v2, s[48:51], 0 offen offset:0 nt
buffer_load_dwordx4 v[236:239], v2, s[48:51], 0 offen offset:256 nt
buffer_load_dwordx4 v[240:243], v2, s[48:51], 0 offen offset:2048 nt
buffer_load_dwordx4 v[244:247], v2, s[48:51], 0 offen offset:2304 nt
v_add_u32 v2, 0x4000, v2
s_mov_b32 exec_lo, 0x1
s_mov_b32 exec_hi, 0x0
v_mov_b32 v44, 14112
v_mov_b32 v45, 1
ds_add_u32 v44, v45
s_mov_b64 exec, -1
s_add_u32 m0, s71, 0
s_nop 0
buffer_load_dwordx4 v1, s[44:47], 0 offen offset:0 nt lds
s_add_u32 m0, s71, 768
s_nop 0
buffer_load_dwordx4 v1, s[44:47], 0 offen offset:256 nt lds
s_add_u32 m0, s71, 0
s_nop 0
buffer_load_dwordx4 v1, s[44:47], 0 offen offset:2048 nt lds
s_add_u32 m0, s71, 768
s_nop 0
buffer_load_dwordx4 v1, s[44:47], 0 offen offset:2304 nt lds
v_add_u32 v1, 0x4000, v1
s_add_u32 m0, s71, 4096
s_nop 0
buffer_load_dwordx4 v2, s[48:51], 0 offen offset:0 nt lds
s_add_u32 m0, s71, 4864
s_nop 0
buffer_load_dwordx4 v2, s[48:51], 0 offen offset:256 nt lds
s_add_u32 m0, s71, 4096
s_nop 0
buffer_load_dwordx4 v2, s[48:51], 0 offen offset:2048 nt lds
s_add_u32 m0, s71, 4864
s_nop 0
buffer_load_dwordx4 v2, s[48:51], 0 offen offset:2304 nt lds
v_add_u32 v2, 0x4000, v2
s_waitcnt vmcnt(55)
s_add_u32 m0, s71, 8192
s_nop 0
buffer_load_dwordx4 v1, s[44:47], 0 offen offset:0 nt lds
s_add_u32 m0, s71, 8960
s_nop 0
buffer_load_dwordx4 v1, s[44:47], 0 offen offset:256 nt lds
s_add_u32 m0, s71, 8192
s_nop 0
buffer_load_dwordx4 v1, s[44:47], 0 offen offset:2048 nt lds
s_add_u32 m0, s71, 8960
s_nop 0
buffer_load_dwordx4 v1, s[44:47], 0 offen offset:2304 nt lds
v_add_u32 v1, 0x4000, v1
s_add_u32 m0, s71, 12288
s_nop 0
buffer_load_dwordx4 v2, s[48:51], 0 offen offset:0 nt lds
s_add_u32 m0, s71, 13056
s_nop 0
buffer_load_dwordx4 v2, s[48:51], 0 offen offset:256 nt lds
s_add_u32 m0, s71, 12288
s_nop 0
buffer_load_dwordx4 v2, s[48:51], 0 offen offset:2048 nt lds
s_add_u32 m0, s71, 13056
s_nop 0
buffer_load_dwordx4 v2, s[48:51], 0 offen offset:2304 nt lds
v_add_u32 v2, 0x4000, v2
s_barrier
ds_read_b128 v[4:7], v50 offset:8960
ds_read_b128 v[8:11], v50 offset:9216
s_waitcnt lgkmcnt(0)
s_waitcnt vmcnt(59)
v_mfma_f32_16x16x32_bf16 v[24:27], v[56:59], v[4:7], 0
v_mfma_f32_16x16x32_bf16 v[28:31], v[64:67], v[4:7], 0
v_mfma_f32_16x16x32_bf16 v[24:27], v[60:63], v[8:11], v[24:27]
v_mfma_f32_16x16x32_bf16 v[28:31], v[68:71], v[8:11], v[28:31]
buffer_load_dwordx4 v[56:59], v1, s[44:47], 0 offen offset:0 nt
buffer_load_dwordx4 v[60:63], v1, s[44:47], 0 offen offset:256 nt
buffer_load_dwordx4 v[64:67], v1, s[44:47], 0 offen offset:2048 nt
buffer_load_dwordx4 v[68:71], v1, s[44:47], 0 offen offset:2304 nt
v_add_u32 v1, 0x4000, v1
s_nop 1
v_mov_b32_dpp v42, v24 quad_perm:[0,0,0,0] row_mask:0xf bank_mask:0xf
v_mov_b32_dpp v43, v28 quad_perm:[0,0,0,0] row_mask:0xf bank_mask:0xf
v_add_f32_dpp v42, v25, v42 quad_perm:[1,1,1,1] row_mask:0xf bank_mask:0xf
v_add_f32_dpp v43, v29, v43 quad_perm:[1,1,1,1] row_mask:0xf bank_mask:0xf
v_add_f32_dpp v42, v26, v42 quad_perm:[2,2,2,2] row_mask:0xf bank_mask:0xf
v_add_f32_dpp v43, v30, v43 quad_perm:[2,2,2,2] row_mask:0xf bank_mask:0xf
v_add_f32_dpp v42, v27, v42 quad_perm:[3,3,3,3] row_mask:0xf bank_mask:0xf
v_add_f32_dpp v43, v31, v43 quad_perm:[3,3,3,3] row_mask:0xf bank_mask:0xf
v_cvt_pk_bf16_f32 v44, v42, v43
v_lshlrev_b32 v42, 16, v44
v_and_b32 v43, 0xffff0000, v44
v_max_f32 v49, v42, v43
v_mov_b32 v44, v49
s_nop 1
v_permlane16_swap_b32 v49, v44
v_max_f32 v49, v49, v44
v_mov_b32 v44, v49
s_nop 1
v_permlane32_swap_b32 v49, v44
v_max_f32 v49, v49, v44
v_max_f32 v49, v49, v40
v_sub_f32 v46, v40, v49
v_sub_f32 v47, v42, v49
v_sub_f32 v48, v43, v49
v_mul_f32 v46, s65, v46
v_mul_f32 v47, s65, v47
v_mul_f32 v48, s65, v48
v_exp_f32 v46, v46
v_exp_f32 v47, v47
v_exp_f32 v48, v48
v_mov_b32 v40, v49
v_cvt_pk_bf16_f32 v44, v47, v47
v_cvt_pk_bf16_f32 v45, v48, v48
v_fma_f32 v41, v41, v46, v47
v_and_b32 v32, v44, v12
v_and_b32 v33, v44, v13
v_and_b32 v34, v44, v14
v_and_b32 v35, v44, v15
v_and_b32 v36, v45, v12
v_and_b32 v37, v45, v13
v_and_b32 v38, v45, v14
v_and_b32 v39, v45, v15
v_add_f32 v41, v41, v48
v_mul_f32 v16, v16, v46
v_mul_f32 v17, v17, v46
v_mul_f32 v18, v18, v46
v_mul_f32 v19, v19, v46
v_mul_f32 v20, v20, v46
v_mul_f32 v21, v21, v46
v_mul_f32 v22, v22, v46
v_mul_f32 v23, v23, v46
s_waitcnt vmcnt(59)
v_mfma_f32_16x16x32_bf16 v[16:19], v[72:75], v[32:35], v[16:19]
v_mfma_f32_16x16x32_bf16 v[20:23], v[76:79], v[32:35], v[20:23]
v_mfma_f32_16x16x32_bf16 v[16:19], v[80:83], v[36:39], v[16:19]
v_mfma_f32_16x16x32_bf16 v[20:23], v[84:87], v[36:39], v[20:23]
buffer_load_dwordx4 v[72:75], v2, s[48:51], 0 offen offset:0 nt
buffer_load_dwordx4 v[76:79], v2, s[48:51], 0 offen offset:256 nt
buffer_load_dwordx4 v[80:83], v2, s[48:51], 0 offen offset:2048 nt
buffer_load_dwordx4 v[84:87], v2, s[48:51], 0 offen offset:2304 nt
v_add_u32 v2, 0x4000, v2
s_waitcnt vmcnt(59)
v_mfma_f32_16x16x32_bf16 v[24:27], v[88:91], v[4:7], 0
v_mfma_f32_16x16x32_bf16 v[28:31], v[96:99], v[4:7], 0
v_mfma_f32_16x16x32_bf16 v[24:27], v[92:95], v[8:11], v[24:27]
v_mfma_f32_16x16x32_bf16 v[28:31], v[100:103], v[8:11], v[28:31]
buffer_load_dwordx4 v[88:91], v1, s[44:47], 0 offen offset:0 nt
buffer_load_dwordx4 v[92:95], v1, s[44:47], 0 offen offset:256 nt
buffer_load_dwordx4 v[96:99], v1, s[44:47], 0 offen offset:2048 nt
buffer_load_dwordx4 v[100:103], v1, s[44:47], 0 offen offset:2304 nt
v_add_u32 v1, 0x4000, v1
s_nop 1
v_mov_b32_dpp v42, v24 quad_perm:[0,0,0,0] row_mask:0xf bank_mask:0xf
v_mov_b32_dpp v43, v28 quad_perm:[0,0,0,0] row_mask:0xf bank_mask:0xf
v_add_f32_dpp v42, v25, v42 quad_perm:[1,1,1,1] row_mask:0xf bank_mask:0xf
v_add_f32_dpp v43, v29, v43 quad_perm:[1,1,1,1] row_mask:0xf bank_mask:0xf
v_add_f32_dpp v42, v26, v42 quad_perm:[2,2,2,2] row_mask:0xf bank_mask:0xf
v_add_f32_dpp v43, v30, v43 quad_perm:[2,2,2,2] row_mask:0xf bank_mask:0xf
v_add_f32_dpp v42, v27, v42 quad_perm:[3,3,3,3] row_mask:0xf bank_mask:0xf
v_add_f32_dpp v43, v31, v43 quad_perm:[3,3,3,3] row_mask:0xf bank_mask:0xf
v_cvt_pk_bf16_f32 v44, v42, v43
v_lshlrev_b32 v42, 16, v44
v_and_b32 v43, 0xffff0000, v44
v_max_f32 v49, v42, v43
v_mov_b32 v44, v49
s_nop 1
v_permlane16_swap_b32 v49, v44
v_max_f32 v49, v49, v44
v_mov_b32 v44, v49
s_nop 1
v_permlane32_swap_b32 v49, v44
v_max_f32 v49, v49, v44
v_max_f32 v49, v49, v40
v_sub_f32 v46, v40, v49
v_sub_f32 v47, v42, v49
v_sub_f32 v48, v43, v49
v_mul_f32 v46, s65, v46
v_mul_f32 v47, s65, v47
v_mul_f32 v48, s65, v48
v_exp_f32 v46, v46
v_exp_f32 v47, v47
v_exp_f32 v48, v48
v_mov_b32 v40, v49
v_cvt_pk_bf16_f32 v44, v47, v47
v_cvt_pk_bf16_f32 v45, v48, v48
v_fma_f32 v41, v41, v46, v47
v_and_b32 v32, v44, v12
v_and_b32 v33, v44, v13
v_and_b32 v34, v44, v14
v_and_b32 v35, v44, v15
v_and_b32 v36, v45, v12
v_and_b32 v37, v45, v13
v_and_b32 v38, v45, v14
v_and_b32 v39, v45, v15
v_add_f32 v41, v41, v48
v_mul_f32 v16, v16, v46
v_mul_f32 v17, v17, v46
v_mul_f32 v18, v18, v46
v_mul_f32 v19, v19, v46
v_mul_f32 v20, v20, v46
v_mul_f32 v21, v21, v46
v_mul_f32 v22, v22, v46
v_mul_f32 v23, v23, v46
s_waitcnt vmcnt(59)
v_mfma_f32_16x16x32_bf16 v[16:19], v[104:107], v[32:35], v[16:19]
v_mfma_f32_16x16x32_bf16 v[20:23], v[108:111], v[32:35], v[20:23]
v_mfma_f32_16x16x32_bf16 v[16:19], v[112:115], v[36:39], v[16:19]
v_mfma_f32_16x16x32_bf16 v[20:23], v[116:119], v[36:39], v[20:23]
buffer_load_dwordx4 v[104:107], v2, s[48:51], 0 offen offset:0 nt
buffer_load_dwordx4 v[108:111], v2, s[48:51], 0 offen offset:256 nt
buffer_load_dwordx4 v[112:115], v2, s[48:51], 0 offen offset:2048 nt
buffer_load_dwordx4 v[116:119], v2, s[48:51], 0 offen offset:2304 nt
v_add_u32 v2, 0x4000, v2
s_waitcnt vmcnt(59)
v_mfma_f32_16x16x32_bf16 v[24:27], v[120:123], v[4:7], 0
v_mfma_f32_16x16x32_bf16 v[28:31], v[128:131], v[4:7], 0
v_mfma_f32_16x16x32_bf16 v[24:27], v[124:127], v[8:11], v[24:27]
v_mfma_f32_16x16x32_bf16 v[28:31], v[132:135], v[8:11], v[28:31]
buffer_load_dwordx4 v[120:123], v1, s[44:47], 0 offen offset:0 nt
buffer_load_dwordx4 v[124:127], v1, s[44:47], 0 offen offset:256 nt
buffer_load_dwordx4 v[128:131], v1, s[44:47], 0 offen offset:2048 nt
buffer_load_dwordx4 v[132:135], v1, s[44:47], 0 offen offset:2304 nt
v_add_u32 v1, 0x4000, v1
s_nop 1
v_mov_b32_dpp v42, v24 quad_perm:[0,0,0,0] row_mask:0xf bank_mask:0xf
v_mov_b32_dpp v43, v28 quad_perm:[0,0,0,0] row_mask:0xf bank_mask:0xf
v_add_f32_dpp v42, v25, v42 quad_perm:[1,1,1,1] row_mask:0xf bank_mask:0xf
v_add_f32_dpp v43, v29, v43 quad_perm:[1,1,1,1] row_mask:0xf bank_mask:0xf
v_add_f32_dpp v42, v26, v42 quad_perm:[2,2,2,2] row_mask:0xf bank_mask:0xf
v_add_f32_dpp v43, v30, v43 quad_perm:[2,2,2,2] row_mask:0xf bank_mask:0xf
v_add_f32_dpp v42, v27, v42 quad_perm:[3,3,3,3] row_mask:0xf bank_mask:0xf
v_add_f32_dpp v43, v31, v43 quad_perm:[3,3,3,3] row_mask:0xf bank_mask:0xf
v_cvt_pk_bf16_f32 v44, v42, v43
v_lshlrev_b32 v42, 16, v44
v_and_b32 v43, 0xffff0000, v44
v_max_f32 v49, v42, v43
v_mov_b32 v44, v49
s_nop 1
v_permlane16_swap_b32 v49, v44
v_max_f32 v49, v49, v44
v_mov_b32 v44, v49
s_nop 1
v_permlane32_swap_b32 v49, v44
v_max_f32 v49, v49, v44
v_max_f32 v49, v49, v40
v_sub_f32 v46, v40, v49
v_sub_f32 v47, v42, v49
v_sub_f32 v48, v43, v49
v_mul_f32 v46, s65, v46
v_mul_f32 v47, s65, v47
v_mul_f32 v48, s65, v48
v_exp_f32 v46, v46
v_exp_f32 v47, v47
v_exp_f32 v48, v48
v_mov_b32 v40, v49
v_cvt_pk_bf16_f32 v44, v47, v47
v_cvt_pk_bf16_f32 v45, v48, v48
v_fma_f32 v41, v41, v46, v47
v_and_b32 v32, v44, v12
v_and_b32 v33, v44, v13
v_and_b32 v34, v44, v14
v_and_b32 v35, v44, v15
v_and_b32 v36, v45, v12
v_and_b32 v37, v45, v13
v_and_b32 v38, v45, v14
v_and_b32 v39, v45, v15
v_add_f32 v41, v41, v48
v_mul_f32 v16, v16, v46
v_mul_f32 v17, v17, v46
v_mul_f32 v18, v18, v46
v_mul_f32 v19, v19, v46
v_mul_f32 v20, v20, v46
v_mul_f32 v21, v21, v46
v_mul_f32 v22, v22, v46
v_mul_f32 v23, v23, v46
s_waitcnt vmcnt(59)
v_mfma_f32_16x16x32_bf16 v[16:19], v[136:139], v[32:35], v[16:19]
v_mfma_f32_16x16x32_bf16 v[20:23], v[140:143], v[32:35], v[20:23]
v_mfma_f32_16x16x32_bf16 v[16:19], v[144:147], v[36:39], v[16:19]
v_mfma_f32_16x16x32_bf16 v[20:23], v[148:151], v[36:39], v[20:23]
buffer_load_dwordx4 v[136:139], v2, s[48:51], 0 offen offset:0 nt
buffer_load_dwordx4 v[140:143], v2, s[48:51], 0 offen offset:256 nt
buffer_load_dwordx4 v[144:147], v2, s[48:51], 0 offen offset:2048 nt
buffer_load_dwordx4 v[148:151], v2, s[48:51], 0 offen offset:2304 nt
v_add_u32 v2, 0x4000, v2
s_waitcnt vmcnt(59)
v_mfma_f32_16x16x32_bf16 v[24:27], v[152:155], v[4:7], 0
v_mfma_f32_16x16x32_bf16 v[28:31], v[160:163], v[4:7], 0
v_mfma_f32_16x16x32_bf16 v[24:27], v[156:159], v[8:11], v[24:27]
v_mfma_f32_16x16x32_bf16 v[28:31], v[164:167], v[8:11], v[28:31]
s_nop 6
v_mov_b32_dpp v42, v24 quad_perm:[0,0,0,0] row_mask:0xf bank_mask:0xf
v_mov_b32_dpp v43, v28 quad_perm:[0,0,0,0] row_mask:0xf bank_mask:0xf
v_add_f32_dpp v42, v25, v42 quad_perm:[1,1,1,1] row_mask:0xf bank_mask:0xf
v_add_f32_dpp v43, v29, v43 quad_perm:[1,1,1,1] row_mask:0xf bank_mask:0xf
v_add_f32_dpp v42, v26, v42 quad_perm:[2,2,2,2] row_mask:0xf bank_mask:0xf
v_add_f32_dpp v43, v30, v43 quad_perm:[2,2,2,2] row_mask:0xf bank_mask:0xf
v_add_f32_dpp v42, v27, v42 quad_perm:[3,3,3,3] row_mask:0xf bank_mask:0xf
v_add_f32_dpp v43, v31, v43 quad_perm:[3,3,3,3] row_mask:0xf bank_mask:0xf
v_cvt_pk_bf16_f32 v44, v42, v43
v_lshlrev_b32 v42, 16, v44
v_and_b32 v43, 0xffff0000, v44
v_max_f32 v49, v42, v43
v_mov_b32 v44, v49
s_nop 1
v_permlane16_swap_b32 v49, v44
v_max_f32 v49, v49, v44
v_mov_b32 v44, v49
s_nop 1
v_permlane32_swap_b32 v49, v44
v_max_f32 v49, v49, v44
v_max_f32 v49, v49, v40
v_sub_f32 v46, v40, v49
v_sub_f32 v47, v42, v49
v_sub_f32 v48, v43, v49
v_mul_f32 v46, s65, v46
v_mul_f32 v47, s65, v47
v_mul_f32 v48, s65, v48
v_exp_f32 v46, v46
v_exp_f32 v47, v47
v_exp_f32 v48, v48
v_mov_b32 v40, v49
v_cvt_pk_bf16_f32 v44, v47, v47
v_cvt_pk_bf16_f32 v45, v48, v48
v_fma_f32 v41, v41, v46, v47
v_and_b32 v32, v44, v12
v_and_b32 v33, v44, v13
v_and_b32 v34, v44, v14
v_and_b32 v35, v44, v15
v_and_b32 v36, v45, v12
v_and_b32 v37, v45, v13
v_and_b32 v38, v45, v14
v_and_b32 v39, v45, v15
v_add_f32 v41, v41, v48
v_mul_f32 v16, v16, v46
v_mul_f32 v17, v17, v46
v_mul_f32 v18, v18, v46
v_mul_f32 v19, v19, v46
v_mul_f32 v20, v20, v46
v_mul_f32 v21, v21, v46
v_mul_f32 v22, v22, v46
v_mul_f32 v23, v23, v46
s_waitcnt vmcnt(56)
v_mfma_f32_16x16x32_bf16 v[16:19], v[168:171], v[32:35], v[16:19]
v_mfma_f32_16x16x32_bf16 v[20:23], v[172:175], v[32:35], v[20:23]
v_mfma_f32_16x16x32_bf16 v[16:19], v[176:179], v[36:39], v[16:19]
v_mfma_f32_16x16x32_bf16 v[20:23], v[180:183], v[36:39], v[20:23]
s_waitcnt vmcnt(52)
v_mfma_f32_16x16x32_bf16 v[24:27], v[184:187], v[4:7], 0
v_mfma_f32_16x16x32_bf16 v[28:31], v[192:195], v[4:7], 0
v_mfma_f32_16x16x32_bf16 v[24:27], v[188:191], v[8:11], v[24:27]
v_mfma_f32_16x16x32_bf16 v[28:31], v[196:199], v[8:11], v[28:31]
s_nop 6
v_mov_b32_dpp v42, v24 quad_perm:[0,0,0,0] row_mask:0xf bank_mask:0xf
v_mov_b32_dpp v43, v28 quad_perm:[0,0,0,0] row_mask:0xf bank_mask:0xf
v_add_f32_dpp v42, v25, v42 quad_perm:[1,1,1,1] row_mask:0xf bank_mask:0xf
v_add_f32_dpp v43, v29, v43 quad_perm:[1,1,1,1] row_mask:0xf bank_mask:0xf
v_add_f32_dpp v42, v26, v42 quad_perm:[2,2,2,2] row_mask:0xf bank_mask:0xf
v_add_f32_dpp v43, v30, v43 quad_perm:[2,2,2,2] row_mask:0xf bank_mask:0xf
v_add_f32_dpp v42, v27, v42 quad_perm:[3,3,3,3] row_mask:0xf bank_mask:0xf
v_add_f32_dpp v43, v31, v43 quad_perm:[3,3,3,3] row_mask:0xf bank_mask:0xf
v_cvt_pk_bf16_f32 v44, v42, v43
v_lshlrev_b32 v42, 16, v44
v_and_b32 v43, 0xffff0000, v44
v_max_f32 v49, v42, v43
v_mov_b32 v44, v49
s_nop 1
v_permlane16_swap_b32 v49, v44
v_max_f32 v49, v49, v44
v_mov_b32 v44, v49
s_nop 1
v_permlane32_swap_b32 v49, v44
v_max_f32 v49, v49, v44
v_max_f32 v49, v49, v40
v_sub_f32 v46, v40, v49
v_sub_f32 v47, v42, v49
v_sub_f32 v48, v43, v49
v_mul_f32 v46, s65, v46
v_mul_f32 v47, s65, v47
v_mul_f32 v48, s65, v48
v_exp_f32 v46, v46
v_exp_f32 v47, v47
v_exp_f32 v48, v48
v_mov_b32 v40, v49
v_cvt_pk_bf16_f32 v44, v47, v47
v_cvt_pk_bf16_f32 v45, v48, v48
v_fma_f32 v41, v41, v46, v47
v_and_b32 v32, v44, v12
v_and_b32 v33, v44, v13
v_and_b32 v34, v44, v14
v_and_b32 v35, v44, v15
v_and_b32 v36, v45, v12
v_and_b32 v37, v45, v13
v_and_b32 v38, v45, v14
v_and_b32 v39, v45, v15
v_add_f32 v41, v41, v48
v_mul_f32 v16, v16, v46
v_mul_f32 v17, v17, v46
v_mul_f32 v18, v18, v46
v_mul_f32 v19, v19, v46
v_mul_f32 v20, v20, v46
v_mul_f32 v21, v21, v46
v_mul_f32 v22, v22, v46
v_mul_f32 v23, v23, v46
s_waitcnt vmcnt(48)
v_mfma_f32_16x16x32_bf16 v[16:19], v[200:203], v[32:35], v[16:19]
v_mfma_f32_16x16x32_bf16 v[20:23], v[204:207], v[32:35], v[20:23]
v_mfma_f32_16x16x32_bf16 v[16:19], v[208:211], v[36:39], v[16:19]
v_mfma_f32_16x16x32_bf16 v[20:23], v[212:215], v[36:39], v[20:23]
s_waitcnt vmcnt(44)
v_mfma_f32_16x16x32_bf16 v[24:27], v[216:219], v[4:7], 0
v_mfma_f32_16x16x32_bf16 v[28:31], v[224:227], v[4:7], 0
v_mfma_f32_16x16x32_bf16 v[24:27], v[220:223], v[8:11], v[24:27]
v_mfma_f32_16x16x32_bf16 v[28:31], v[228:231], v[8:11], v[28:31]
s_nop 6
v_mov_b32_dpp v42, v24 quad_perm:[0,0,0,0] row_mask:0xf bank_mask:0xf
v_mov_b32_dpp v43, v28 quad_perm:[0,0,0,0] row_mask:0xf bank_mask:0xf
v_add_f32_dpp v42, v25, v42 quad_perm:[1,1,1,1] row_mask:0xf bank_mask:0xf
v_add_f32_dpp v43, v29, v43 quad_perm:[1,1,1,1] row_mask:0xf bank_mask:0xf
v_add_f32_dpp v42, v26, v42 quad_perm:[2,2,2,2] row_mask:0xf bank_mask:0xf
v_add_f32_dpp v43, v30, v43 quad_perm:[2,2,2,2] row_mask:0xf bank_mask:0xf
v_add_f32_dpp v42, v27, v42 quad_perm:[3,3,3,3] row_mask:0xf bank_mask:0xf
v_add_f32_dpp v43, v31, v43 quad_perm:[3,3,3,3] row_mask:0xf bank_mask:0xf
v_cvt_pk_bf16_f32 v44, v42, v43
v_lshlrev_b32 v42, 16, v44
v_and_b32 v43, 0xffff0000, v44
v_max_f32 v49, v42, v43
v_mov_b32 v44, v49
s_nop 1
v_permlane16_swap_b32 v49, v44
v_max_f32 v49, v49, v44
v_mov_b32 v44, v49
s_nop 1
v_permlane32_swap_b32 v49, v44
v_max_f32 v49, v49, v44
v_max_f32 v49, v49, v40
v_sub_f32 v46, v40, v49
v_sub_f32 v47, v42, v49
v_sub_f32 v48, v43, v49
v_mul_f32 v46, s65, v46
v_mul_f32 v47, s65, v47
v_mul_f32 v48, s65, v48
v_exp_f32 v46, v46
v_exp_f32 v47, v47
v_exp_f32 v48, v48
v_mov_b32 v40, v49
v_cvt_pk_bf16_f32 v44, v47, v47
v_cvt_pk_bf16_f32 v45, v48, v48
v_fma_f32 v41, v41, v46, v47
v_and_b32 v32, v44, v12
v_and_b32 v33, v44, v13
v_and_b32 v34, v44, v14
v_and_b32 v35, v44, v15
v_and_b32 v36, v45, v12
v_and_b32 v37, v45, v13
v_and_b32 v38, v45, v14
v_and_b32 v39, v45, v15
v_add_f32 v41, v41, v48
v_mul_f32 v16, v16, v46
v_mul_f32 v17, v17, v46
v_mul_f32 v18, v18, v46
v_mul_f32 v19, v19, v46
v_mul_f32 v20, v20, v46
v_mul_f32 v21, v21, v46
v_mul_f32 v22, v22, v46
v_mul_f32 v23, v23, v46
s_waitcnt vmcnt(40)
v_mfma_f32_16x16x32_bf16 v[16:19], v[232:235], v[32:35], v[16:19]
v_mfma_f32_16x16x32_bf16 v[20:23], v[236:239], v[32:35], v[20:23]
v_mfma_f32_16x16x32_bf16 v[16:19], v[240:243], v[36:39], v[16:19]
v_mfma_f32_16x16x32_bf16 v[20:23], v[244:247], v[36:39], v[20:23]
s_waitcnt vmcnt(36)
ds_read_b128 v[248:251], v52 offset:18432
ds_read_b128 v[252:255], v52 offset:19456
s_waitcnt lgkmcnt(0)
v_mfma_f32_16x16x32_bf16 v[24:27], v[248:251], v[4:7], 0
v_mfma_f32_16x16x32_bf16 v[24:27], v[252:255], v[8:11], v[24:27]
s_nop 7
ds_read_b128 v[248:251], v52 offset:20480
ds_read_b128 v[252:255], v52 offset:21504
s_waitcnt lgkmcnt(0)
v_mfma_f32_16x16x32_bf16 v[28:31], v[248:251], v[4:7], 0
v_mfma_f32_16x16x32_bf16 v[28:31], v[252:255], v[8:11], v[28:31]
s_nop 7
v_mov_b32_dpp v42, v24 quad_perm:[0,0,0,0] row_mask:0xf bank_mask:0xf
v_mov_b32_dpp v43, v28 quad_perm:[0,0,0,0] row_mask:0xf bank_mask:0xf
v_add_f32_dpp v42, v25, v42 quad_perm:[1,1,1,1] row_mask:0xf bank_mask:0xf
v_add_f32_dpp v43, v29, v43 quad_perm:[1,1,1,1] row_mask:0xf bank_mask:0xf
v_add_f32_dpp v42, v26, v42 quad_perm:[2,2,2,2] row_mask:0xf bank_mask:0xf
v_add_f32_dpp v43, v30, v43 quad_perm:[2,2,2,2] row_mask:0xf bank_mask:0xf
v_add_f32_dpp v42, v27, v42 quad_perm:[3,3,3,3] row_mask:0xf bank_mask:0xf
v_add_f32_dpp v43, v31, v43 quad_perm:[3,3,3,3] row_mask:0xf bank_mask:0xf
v_cvt_pk_bf16_f32 v44, v42, v43
v_lshlrev_b32 v42, 16, v44
v_and_b32 v43, 0xffff0000, v44
v_max_f32 v49, v42, v43
v_mov_b32 v44, v49
s_nop 1
v_permlane16_swap_b32 v49, v44
v_max_f32 v49, v49, v44
v_mov_b32 v44, v49
s_nop 1
v_permlane32_swap_b32 v49, v44
v_max_f32 v49, v49, v44
v_max_f32 v49, v49, v40
v_sub_f32 v46, v40, v49
v_sub_f32 v47, v42, v49
v_sub_f32 v48, v43, v49
v_mul_f32 v46, s65, v46
v_mul_f32 v47, s65, v47
v_mul_f32 v48, s65, v48
v_exp_f32 v46, v46
v_exp_f32 v47, v47
v_exp_f32 v48, v48
v_mov_b32 v40, v49
v_cvt_pk_bf16_f32 v44, v47, v47
v_cvt_pk_bf16_f32 v45, v48, v48
v_fma_f32 v41, v41, v46, v47
v_and_b32 v32, v44, v12
v_and_b32 v33, v44, v13
v_and_b32 v34, v44, v14
v_and_b32 v35, v44, v15
v_and_b32 v36, v45, v12
v_and_b32 v37, v45, v13
v_and_b32 v38, v45, v14
v_and_b32 v39, v45, v15
v_add_f32 v41, v41, v48
v_mul_f32 v16, v16, v46
v_mul_f32 v17, v17, v46
v_mul_f32 v18, v18, v46
v_mul_f32 v19, v19, v46
v_mul_f32 v20, v20, v46
v_mul_f32 v21, v21, v46
v_mul_f32 v22, v22, v46
v_mul_f32 v23, v23, v46
s_waitcnt vmcnt(32)
ds_read_b128 v[248:251], v52 offset:22528
ds_read_b128 v[252:255], v52 offset:23552
s_waitcnt lgkmcnt(0)
v_mfma_f32_16x16x32_bf16 v[16:19], v[248:251], v[32:35], v[16:19]
v_mfma_f32_16x16x32_bf16 v[20:23], v[252:255], v[32:35], v[20:23]
s_nop 7
ds_read_b128 v[248:251], v52 offset:24576
ds_read_b128 v[252:255], v52 offset:25600
s_waitcnt lgkmcnt(0)
v_mfma_f32_16x16x32_bf16 v[16:19], v[248:251], v[36:39], v[16:19]
v_mfma_f32_16x16x32_bf16 v[20:23], v[252:255], v[36:39], v[20:23]
s_nop 7
s_waitcnt vmcnt(28)
ds_read_b128 v[248:251], v52 offset:26624
ds_read_b128 v[252:255], v52 offset:27648
s_waitcnt lgkmcnt(0)
v_mfma_f32_16x16x32_bf16 v[24:27], v[248:251], v[4:7], 0
v_mfma_f32_16x16x32_bf16 v[24:27], v[252:255], v[8:11], v[24:27]
s_nop 7
ds_read_b128 v[248:251], v52 offset:28672
ds_read_b128 v[252:255], v52 offset:29696
s_waitcnt lgkmcnt(0)
v_mfma_f32_16x16x32_bf16 v[28:31], v[248:251], v[4:7], 0
v_mfma_f32_16x16x32_bf16 v[28:31], v[252:255], v[8:11], v[28:31]
s_nop 7
v_mov_b32_dpp v42, v24 quad_perm:[0,0,0,0] row_mask:0xf bank_mask:0xf
v_mov_b32_dpp v43, v28 quad_perm:[0,0,0,0] row_mask:0xf bank_mask:0xf
v_add_f32_dpp v42, v25, v42 quad_perm:[1,1,1,1] row_mask:0xf bank_mask:0xf
v_add_f32_dpp v43, v29, v43 quad_perm:[1,1,1,1] row_mask:0xf bank_mask:0xf
v_add_f32_dpp v42, v26, v42 quad_perm:[2,2,2,2] row_mask:0xf bank_mask:0xf
v_add_f32_dpp v43, v30, v43 quad_perm:[2,2,2,2] row_mask:0xf bank_mask:0xf
v_add_f32_dpp v42, v27, v42 quad_perm:[3,3,3,3] row_mask:0xf bank_mask:0xf
v_add_f32_dpp v43, v31, v43 quad_perm:[3,3,3,3] row_mask:0xf bank_mask:0xf
v_cvt_pk_bf16_f32 v44, v42, v43
v_lshlrev_b32 v42, 16, v44
v_and_b32 v43, 0xffff0000, v44
v_max_f32 v49, v42, v43
v_mov_b32 v44, v49
s_nop 1
v_permlane16_swap_b32 v49, v44
v_max_f32 v49, v49, v44
v_mov_b32 v44, v49
s_nop 1
v_permlane32_swap_b32 v49, v44
v_max_f32 v49, v49, v44
v_max_f32 v49, v49, v40
v_sub_f32 v46, v40, v49
v_sub_f32 v47, v42, v49
v_sub_f32 v48, v43, v49
v_mul_f32 v46, s65, v46
v_mul_f32 v47, s65, v47
v_mul_f32 v48, s65, v48
v_exp_f32 v46, v46
v_exp_f32 v47, v47
v_exp_f32 v48, v48
v_mov_b32 v40, v49
v_cvt_pk_bf16_f32 v44, v47, v47
v_cvt_pk_bf16_f32 v45, v48, v48
v_fma_f32 v41, v41, v46, v47
v_and_b32 v32, v44, v12
v_and_b32 v33, v44, v13
v_and_b32 v34, v44, v14
v_and_b32 v35, v44, v15
v_and_b32 v36, v45, v12
v_and_b32 v37, v45, v13
v_and_b32 v38, v45, v14
v_and_b32 v39, v45, v15
v_add_f32 v41, v41, v48
v_mul_f32 v16, v16, v46
v_mul_f32 v17, v17, v46
v_mul_f32 v18, v18, v46
v_mul_f32 v19, v19, v46
v_mul_f32 v20, v20, v46
v_mul_f32 v21, v21, v46
v_mul_f32 v22, v22, v46
v_mul_f32 v23, v23, v46
s_waitcnt vmcnt(24)
ds_read_b128 v[248:251], v52 offset:30720
ds_read_b128 v[252:255], v52 offset:31744
s_waitcnt lgkmcnt(0)
v_mfma_f32_16x16x32_bf16 v[16:19], v[248:251], v[32:35], v[16:19]
v_mfma_f32_16x16x32_bf16 v[20:23], v[252:255], v[32:35], v[20:23]
s_nop 7
ds_read_b128 v[248:251], v52 offset:32768
ds_read_b128 v[252:255], v52 offset:33792
s_waitcnt lgkmcnt(0)
v_mfma_f32_16x16x32_bf16 v[16:19], v[248:251], v[36:39], v[16:19]
v_mfma_f32_16x16x32_bf16 v[20:23], v[252:255], v[36:39], v[20:23]
s_nop 7
s_mov_b32 exec_lo, 0x1
s_mov_b32 exec_hi, 0x0
v_mov_b32 v44, 14124
v_mov_b32 v45, 1
ds_add_u32 v44, v45
s_mov_b64 exec, -1
s_mov_b32 s87, 8
s_mov_b32 s56, 11
v_mov_b32 v251, 0
v_mov_b32 v248, -1
v_mov_b32 v250, 0
s_nop 0
s_branch L_loop
L_pwg:
s_barrier
v_mov_b32 v16, 0
v_mov_b32 v17, 0
v_mov_b32 v18, 0
v_mov_b32 v19, 0
v_mov_b32 v20, 0
v_mov_b32 v21, 0
v_mov_b32 v22, 0
v_mov_b32 v23, 0
v_mov_b32 v40, 0xff61b1e6
v_mov_b32 v41, 0
s_barrier
buffer_load_dwordx4 v[56:59], v1, s[44:47], 0 offen offset:0 nt
buffer_load_dwordx4 v[60:63], v1, s[44:47], 0 offen offset:256 nt
buffer_load_dwordx4 v[64:67], v1, s[44:47], 0 offen offset:2048 nt
buffer_load_dwordx4 v[68:71], v1, s[44:47], 0 offen offset:2304 nt
v_add_u32 v1, 0x4000, v1
buffer_load_dwordx4 v[72:75], v2, s[48:51], 0 offen offset:0 nt
buffer_load_dwordx4 v[76:79], v2, s[48:51], 0 offen offset:256 nt
buffer_load_dwordx4 v[80:83], v2, s[48:51], 0 offen offset:2048 nt
buffer_load_dwordx4 v[84:87], v2, s[48:51], 0 offen offset:2304 nt
v_add_u32 v2, 0x4000, v2
buffer_load_dwordx4 v[88:91], v1, s[44:47], 0 offen offset:0 nt
buffer_load_dwordx4 v[92:95], v1, s[44:47], 0 offen offset:256 nt
buffer_load_dwordx4 v[96:99], v1, s[44:47], 0 offen offset:2048 nt
buffer_load_dwordx4 v[100:103], v1, s[44:47], 0 offen offset:2304 nt
v_add_u32 v1, 0x4000, v1
buffer_load_dwordx4 v[104:107], v2, s[48:51], 0 offen offset:0 nt
buffer_load_dwordx4 v[108:111], v2, s[48:51], 0 offen offset:256 nt
buffer_load_dwordx4 v[112:115], v2, s[48:51], 0 offen offset:2048 nt
buffer_load_dwordx4 v[116:119], v2, s[48:51], 0 offen offset:2304 nt
v_add_u32 v2, 0x4000, v2
buffer_load_dwordx4 v[120:123], v1, s[44:47], 0 offen offset:0 nt
buffer_load_dwordx4 v[124:127], v1, s[44:47], 0 offen offset:256 nt
buffer_load_dwordx4 v[128:131], v1, s[44:47], 0 offen offset:2048 nt
buffer_load_dwordx4 v[132:135], v1, s[44:47], 0 offen offset:2304 nt
v_add_u32 v1, 0x4000, v1
buffer_load_dwordx4 v[136:139], v2, s[48:51], 0 offen offset:0 nt
buffer_load_dwordx4 v[140:143], v2, s[48:51], 0 offen offset:256 nt
buffer_load_dwordx4 v[144:147], v2, s[48:51], 0 offen offset:2048 nt
buffer_load_dwordx4 v[148:151], v2, s[48:51], 0 offen offset:2304 nt
v_add_u32 v2, 0x4000, v2
s_barrier
ds_read_b128 v[4:7], v50 offset:8960
ds_read_b128 v[8:11], v50 offset:9216
s_waitcnt lgkmcnt(0)
s_mov_b32 exec_lo, 0x1
s_mov_b32 exec_hi, 0x0
v_mov_b32 v44, 14124
v_mov_b32 v45, 1
ds_add_u32 v44, v45
s_mov_b64 exec, -1
s_mov_b32 s87, 0
s_mov_b32 s56, 3
v_mov_b32 v251, 0
v_mov_b32 v248, -1
v_mov_b32 v250, 0
s_nop 1
L_loop:
s_waitcnt vmcnt(20)
v_mfma_f32_16x16x32_bf16 v[24:27], v[56:59], v[4:7], 0
v_mfma_f32_16x16x32_bf16 v[28:31], v[64:67], v[4:7], 0
v_mfma_f32_16x16x32_bf16 v[24:27], v[60:63], v[8:11], v[24:27]
v_mfma_f32_16x16x32_bf16 v[28:31], v[68:71], v[8:11], v[28:31]
s_cmp_lt_u32 s56, s57
s_nop 5
s_cbranch_scc1 L_st_1
s_cmp_lg_u32 s58, 0
s_cbranch_scc1 L_inv_3
s_mov_b32 s72, 200000
L_re_4:
s_waitcnt lgkmcnt(0)
v_readfirstlane_b32 s70, v248
s_cmp_lg_u32 s70, -1
s_nop 2
s_cbranch_scc1 L_re_4_ok
ds_read_b32 v248, v250 offset:17920
s_sub_u32 s72, s72, 1
s_cbranch_scc0 L_re_4
L_re_4_ok:
s_cmp_lt_u32 s70, 256
s_cbranch_scc0 L_exh_2
s_lshl_b32 s70, s70, 14
v_add_u32 v1, s70, v3
v_add_u32 v2, s70, v53
s_nop 0
s_branch L_st_1
L_exh_2:
s_mov_b32 s58, 1
s_mov_b32 s86, s56
L_inv_3:
v_mov_b32 v1, 0x40000000
v_mov_b32 v2, 0x40000000
s_nop 1
L_st_1:
buffer_load_dwordx4 v[56:59], v1, s[44:47], 0 offen offset:0 nt
buffer_load_dwordx4 v[60:63], v1, s[44:47], 0 offen offset:256 nt
buffer_load_dwordx4 v[64:67], v1, s[44:47], 0 offen offset:2048 nt
buffer_load_dwordx4 v[68:71], v1, s[44:47], 0 offen offset:2304 nt
v_add_u32 v1, 0x4000, v1
v_mov_b32_dpp v42, v24 quad_perm:[0,0,0,0] row_mask:0xf bank_mask:0xf
v_mov_b32_dpp v43, v28 quad_perm:[0,0,0,0] row_mask:0xf bank_mask:0xf
v_add_f32_dpp v42, v25, v42 quad_perm:[1,1,1,1] row_mask:0xf bank_mask:0xf
v_add_f32_dpp v43, v29, v43 quad_perm:[1,1,1,1] row_mask:0xf bank_mask:0xf
v_add_f32_dpp v42, v26, v42 quad_perm:[2,2,2,2] row_mask:0xf bank_mask:0xf
v_add_f32_dpp v43, v30, v43 quad_perm:[2,2,2,2] row_mask:0xf bank_mask:0xf
v_add_f32_dpp v42, v27, v42 quad_perm:[3,3,3,3] row_mask:0xf bank_mask:0xf
v_add_f32_dpp v43, v31, v43 quad_perm:[3,3,3,3] row_mask:0xf bank_mask:0xf
v_cvt_pk_bf16_f32 v44, v42, v43
v_lshlrev_b32 v42, 16, v44
v_and_b32 v43, 0xffff0000, v44
v_max_f32 v49, v42, v43
v_mov_b32 v44, v49
s_nop 1
v_permlane16_swap_b32 v49, v44
v_max_f32 v49, v49, v44
v_mov_b32 v44, v49
s_nop 1
v_permlane32_swap_b32 v49, v44
v_max_f32 v49, v49, v44
v_max_f32 v49, v49, v40
v_sub_f32 v46, v40, v49
v_sub_f32 v47, v42, v49
v_sub_f32 v48, v43, v49
v_mul_f32 v46, s65, v46
v_mul_f32 v47, s65, v47
v_mul_f32 v48, s65, v48
v_exp_f32 v46, v46
v_exp_f32 v47, v47
v_exp_f32 v48, v48
v_mov_b32 v40, v49
v_cvt_pk_bf16_f32 v44, v47, v47
v_cvt_pk_bf16_f32 v45, v48, v48
v_fma_f32 v41, v41, v46, v47
v_and_b32 v32, v44, v12
v_and_b32 v33, v44, v13
v_and_b32 v34, v44, v14
v_and_b32 v35, v44, v15
v_and_b32 v36, v45, v12
v_and_b32 v37, v45, v13
v_and_b32 v38, v45, v14
v_and_b32 v39, v45, v15
v_add_f32 v41, v41, v48
v_mul_f32 v16, v16, v46
v_mul_f32 v17, v17, v46
v_mul_f32 v18, v18, v46
v_mul_f32 v19, v19, v46
v_mul_f32 v20, v20, v46
v_mul_f32 v21, v21, v46
v_mul_f32 v22, v22, v46
v_mul_f32 v23, v23, v46
s_waitcnt vmcnt(20)
v_mfma_f32_16x16x32_bf16 v[16:19], v[72:75], v[32:35], v[16:19]
v_mfma_f32_16x16x32_bf16 v[20:23], v[76:79], v[32:35], v[20:23]
v_mfma_f32_16x16x32_bf16 v[16:19], v[80:83], v[36:39], v[16:19]
v_mfma_f32_16x16x32_bf16 v[20:23], v[84:87], v[36:39], v[20:23]
buffer_load_dwordx4 v[72:75], v2, s[48:51], 0 offen offset:0 nt
buffer_load_dwordx4 v[76:79], v2, s[48:51], 0 offen offset:256 nt
buffer_load_dwordx4 v[80:83], v2, s[48:51], 0 offen offset:2048 nt
buffer_load_dwordx4 v[84:87], v2, s[48:51], 0 offen offset:2304 nt
v_add_u32 v2, 0x4000, v2
s_add_u32 s56, s56, 1
s_lshl_b32 s70, s56, 2
v_mov_b32 v250, s70
v_mov_b32 v249, s56
ds_read_b32 v248, v250 offset:17920
s_mov_b64 exec, 1
ds_max_u32 v251, v249 offset:17888
s_mov_b64 exec, -1
s_add_u32 s87, s87, 1
s_cmp_ge_u32 s87, s86
s_cbranch_scc1 L_sdone
s_waitcnt vmcnt(20)
v_mfma_f32_16x16x32_bf16 v[24:27], v[88:91], v[4:7], 0
v_mfma_f32_16x16x32_bf16 v[28:31], v[96:99], v[4:7], 0
v_mfma_f32_16x16x32_bf16 v[24:27], v[92:95], v[8:11], v[24:27]
v_mfma_f32_16x16x32_bf16 v[28:31], v[100:103], v[8:11], v[28:31]
s_cmp_lt_u32 s56, s57
s_nop 5
s_cbranch_scc1 L_st_5
s_cmp_lg_u32 s58, 0
s_cbranch_scc1 L_inv_7
s_mov_b32 s72, 200000
L_re_8:
s_waitcnt lgkmcnt(0)
v_readfirstlane_b32 s70, v248
s_cmp_lg_u32 s70, -1
s_nop 2
s_cbranch_scc1 L_re_8_ok
ds_read_b32 v248, v250 offset:17920
s_sub_u32 s72, s72, 1
s_cbranch_scc0 L_re_8
L_re_8_ok:
s_cmp_lt_u32 s70, 256
s_cbranch_scc0 L_exh_6
s_lshl_b32 s70, s70, 14
v_add_u32 v1, s70, v3
v_add_u32 v2, s70, v53
s_nop 0
s_branch L_st_5
L_exh_6:
s_mov_b32 s58, 1
s_mov_b32 s86, s56
L_inv_7:
v_mov_b32 v1, 0x40000000
v_mov_b32 v2, 0x40000000
s_nop 1
L_st_5:
buffer_load_dwordx4 v[88:91], v1, s[44:47], 0 offen offset:0 nt
buffer_load_dwordx4 v[92:95], v1, s[44:47], 0 offen offset:256 nt
buffer_load_dwordx4 v[96:99], v1, s[44:47], 0 offen offset:2048 nt
buffer_load_dwordx4 v[100:103], v1, s[44:47], 0 offen offset:2304 nt
v_add_u32 v1, 0x4000, v1
v_mov_b32_dpp v42, v24 quad_perm:[0,0,0,0] row_mask:0xf bank_mask:0xf
v_mov_b32_dpp v43, v28 quad_perm:[0,0,0,0] row_mask:0xf bank_mask:0xf
v_add_f32_dpp v42, v25, v42 quad_perm:[1,1,1,1] row_mask:0xf bank_mask:0xf
v_add_f32_dpp v43, v29, v43 quad_perm:[1,1,1,1] row_mask:0xf bank_mask:0xf
v_add_f32_dpp v42, v26, v42 quad_perm:[2,2,2,2] row_mask:0xf bank_mask:0xf
v_add_f32_dpp v43, v30, v43 quad_perm:[2,2,2,2] row_mask:0xf bank_mask:0xf
v_add_f32_dpp v42, v27, v42 quad_perm:[3,3,3,3] row_mask:0xf bank_mask:0xf
v_add_f32_dpp v43, v31, v43 quad_perm:[3,3,3,3] row_mask:0xf bank_mask:0xf
v_cvt_pk_bf16_f32 v44, v42, v43
v_lshlrev_b32 v42, 16, v44
v_and_b32 v43, 0xffff0000, v44
v_max_f32 v49, v42, v43
v_mov_b32 v44, v49
s_nop 1
v_permlane16_swap_b32 v49, v44
v_max_f32 v49, v49, v44
v_mov_b32 v44, v49
s_nop 1
v_permlane32_swap_b32 v49, v44
v_max_f32 v49, v49, v44
v_max_f32 v49, v49, v40
v_sub_f32 v46, v40, v49
v_sub_f32 v47, v42, v49
v_sub_f32 v48, v43, v49
v_mul_f32 v46, s65, v46
v_mul_f32 v47, s65, v47
v_mul_f32 v48, s65, v48
v_exp_f32 v46, v46
v_exp_f32 v47, v47
v_exp_f32 v48, v48
v_mov_b32 v40, v49
v_cvt_pk_bf16_f32 v44, v47, v47
v_cvt_pk_bf16_f32 v45, v48, v48
v_fma_f32 v41, v41, v46, v47
v_and_b32 v32, v44, v12
v_and_b32 v33, v44, v13
v_and_b32 v34, v44, v14
v_and_b32 v35, v44, v15
v_and_b32 v36, v45, v12
v_and_b32 v37, v45, v13
v_and_b32 v38, v45, v14
v_and_b32 v39, v45, v15
v_add_f32 v41, v41, v48
v_mul_f32 v16, v16, v46
v_mul_f32 v17, v17, v46
v_mul_f32 v18, v18, v46
v_mul_f32 v19, v19, v46
v_mul_f32 v20, v20, v46
v_mul_f32 v21, v21, v46
v_mul_f32 v22, v22, v46
v_mul_f32 v23, v23, v46
s_waitcnt vmcnt(20)
v_mfma_f32_16x16x32_bf16 v[16:19], v[104:107], v[32:35], v[16:19]
v_mfma_f32_16x16x32_bf16 v[20:23], v[108:111], v[32:35], v[20:23]
v_mfma_f32_16x16x32_bf16 v[16:19], v[112:115], v[36:39], v[16:19]
v_mfma_f32_16x16x32_bf16 v[20:23], v[116:119], v[36:39], v[20:23]
buffer_load_dwordx4 v[104:107], v2, s[48:51], 0 offen offset:0 nt
buffer_load_dwordx4 v[108:111], v2, s[48:51], 0 offen offset:256 nt
buffer_load_dwordx4 v[112:115], v2, s[48:51], 0 offen offset:2048 nt
buffer_load_dwordx4 v[116:119], v2, s[48:51], 0 offen offset:2304 nt
v_add_u32 v2, 0x4000, v2
s_add_u32 s56, s56, 1
s_lshl_b32 s70, s56, 2
v_mov_b32 v250, s70
v_mov_b32 v249, s56
ds_read_b32 v248, v250 offset:17920
s_mov_b64 exec, 1
ds_max_u32 v251, v249 offset:17888
s_mov_b64 exec, -1
s_add_u32 s87, s87, 1
s_cmp_ge_u32 s87, s86
s_cbranch_scc1 L_sdone
s_waitcnt vmcnt(20)
v_mfma_f32_16x16x32_bf16 v[24:27], v[120:123], v[4:7], 0
v_mfma_f32_16x16x32_bf16 v[28:31], v[128:131], v[4:7], 0
v_mfma_f32_16x16x32_bf16 v[24:27], v[124:127], v[8:11], v[24:27]
v_mfma_f32_16x16x32_bf16 v[28:31], v[132:135], v[8:11], v[28:31]
s_cmp_lt_u32 s56, s57
s_nop 5
s_cbranch_scc1 L_st_9
s_cmp_lg_u32 s58, 0
s_cbranch_scc1 L_inv_11
s_mov_b32 s72, 200000
L_re_12:
s_waitcnt lgkmcnt(0)
v_readfirstlane_b32 s70, v248
s_cmp_lg_u32 s70, -1
s_nop 2
s_cbranch_scc1 L_re_12_ok
ds_read_b32 v248, v250 offset:17920
s_sub_u32 s72, s72, 1
s_cbranch_scc0 L_re_12
L_re_12_ok:
s_cmp_lt_u32 s70, 256
s_cbranch_scc0 L_exh_10
s_lshl_b32 s70, s70, 14
v_add_u32 v1, s70, v3
v_add_u32 v2, s70, v53
s_nop 0
s_branch L_st_9
L_exh_10:
s_mov_b32 s58, 1
s_mov_b32 s86, s56
L_inv_11:
v_mov_b32 v1, 0x40000000
v_mov_b32 v2, 0x40000000
s_nop 1
L_st_9:
buffer_load_dwordx4 v[120:123], v1, s[44:47], 0 offen offset:0 nt
buffer_load_dwordx4 v[124:127], v1, s[44:47], 0 offen offset:256 nt
buffer_load_dwordx4 v[128:131], v1, s[44:47], 0 offen offset:2048 nt
buffer_load_dwordx4 v[132:135], v1, s[44:47], 0 offen offset:2304 nt
v_add_u32 v1, 0x4000, v1
v_mov_b32_dpp v42, v24 quad_perm:[0,0,0,0] row_mask:0xf bank_mask:0xf
v_mov_b32_dpp v43, v28 quad_perm:[0,0,0,0] row_mask:0xf bank_mask:0xf
v_add_f32_dpp v42, v25, v42 quad_perm:[1,1,1,1] row_mask:0xf bank_mask:0xf
v_add_f32_dpp v43, v29, v43 quad_perm:[1,1,1,1] row_mask:0xf bank_mask:0xf
v_add_f32_dpp v42, v26, v42 quad_perm:[2,2,2,2] row_mask:0xf bank_mask:0xf
v_add_f32_dpp v43, v30, v43 quad_perm:[2,2,2,2] row_mask:0xf bank_mask:0xf
v_add_f32_dpp v42, v27, v42 quad_perm:[3,3,3,3] row_mask:0xf bank_mask:0xf
v_add_f32_dpp v43, v31, v43 quad_perm:[3,3,3,3] row_mask:0xf bank_mask:0xf
v_cvt_pk_bf16_f32 v44, v42, v43
v_lshlrev_b32 v42, 16, v44
v_and_b32 v43, 0xffff0000, v44
v_max_f32 v49, v42, v43
v_mov_b32 v44, v49
s_nop 1
v_permlane16_swap_b32 v49, v44
v_max_f32 v49, v49, v44
v_mov_b32 v44, v49
s_nop 1
v_permlane32_swap_b32 v49, v44
v_max_f32 v49, v49, v44
v_max_f32 v49, v49, v40
v_sub_f32 v46, v40, v49
v_sub_f32 v47, v42, v49
v_sub_f32 v48, v43, v49
v_mul_f32 v46, s65, v46
v_mul_f32 v47, s65, v47
v_mul_f32 v48, s65, v48
v_exp_f32 v46, v46
v_exp_f32 v47, v47
v_exp_f32 v48, v48
v_mov_b32 v40, v49
v_cvt_pk_bf16_f32 v44, v47, v47
v_cvt_pk_bf16_f32 v45, v48, v48
v_fma_f32 v41, v41, v46, v47
v_and_b32 v32, v44, v12
v_and_b32 v33, v44, v13
v_and_b32 v34, v44, v14
v_and_b32 v35, v44, v15
v_and_b32 v36, v45, v12
v_and_b32 v37, v45, v13
v_and_b32 v38, v45, v14
v_and_b32 v39, v45, v15
v_add_f32 v41, v41, v48
v_mul_f32 v16, v16, v46
v_mul_f32 v17, v17, v46
v_mul_f32 v18, v18, v46
v_mul_f32 v19, v19, v46
v_mul_f32 v20, v20, v46
v_mul_f32 v21, v21, v46
v_mul_f32 v22, v22, v46
v_mul_f32 v23, v23, v46
s_waitcnt vmcnt(20)
v_mfma_f32_16x16x32_bf16 v[16:19], v[136:139], v[32:35], v[16:19]
v_mfma_f32_16x16x32_bf16 v[20:23], v[140:143], v[32:35], v[20:23]
v_mfma_f32_16x16x32_bf16 v[16:19], v[144:147], v[36:39], v[16:19]
v_mfma_f32_16x16x32_bf16 v[20:23], v[148:151], v[36:39], v[20:23]
buffer_load_dwordx4 v[136:139], v2, s[48:51], 0 offen offset:0 nt
buffer_load_dwordx4 v[140:143], v2, s[48:51], 0 offen offset:256 nt
buffer_load_dwordx4 v[144:147], v2, s[48:51], 0 offen offset:2048 nt
buffer_load_dwordx4 v[148:151], v2, s[48:51], 0 offen offset:2304 nt
v_add_u32 v2, 0x4000, v2
s_add_u32 s56, s56, 1
s_lshl_b32 s70, s56, 2
v_mov_b32 v250, s70
v_mov_b32 v249, s56
ds_read_b32 v248, v250 offset:17920
s_mov_b64 exec, 1
ds_max_u32 v251, v249 offset:17888
s_mov_b64 exec, -1
s_add_u32 s87, s87, 1
s_cmp_ge_u32 s87, s86
s_cbranch_scc0 L_loop
L_sdone:
v_mov_b32 v44, v41
s_nop 1
v_permlane16_swap_b32 v41, v44
v_add_f32 v41, v41, v44
v_mov_b32 v44, v41
s_nop 1
v_permlane32_swap_b32 v41, v44
v_add_f32 v41, v41, v44
ds_write_b32 v51, v16 offset:9984
ds_write_b32 v51, v17 offset:10016
ds_write_b32 v51, v18 offset:10048
ds_write_b32 v51, v19 offset:10080
ds_write_b32 v51, v20 offset:10496
ds_write_b32 v51, v21 offset:10528
ds_write_b32 v51, v22 offset:10560
ds_write_b32 v51, v23 offset:10592
s_lshl_b32 s70, s42, 3
v_mov_b32 v53, s70
ds_write_b32 v53, v40 offset:14080
ds_write_b32 v53, v41 offset:14084
s_waitcnt lgkmcnt(0)
s_barrier
s_endpgm
L_service:
s_setprio 3
s_sub_u32 s42, s37, 4
v_and_b32 v2, 15, v0
v_lshrrev_b32 v3, 4, v0
s_mul_i32 s89, s42, 1792
v_lshlrev_b32 v8, 3, v3
v_lshrrev_b32 v9, 2, v2
v_add_u32 v5, v8, v9
v_and_b32 v6, 3, v2
v_and_b32 v8, 1, v2
v_mul_u32_u24 v8, 896, v8
v_lshlrev_b32 v9, 4, v3
v_add3_u32 v4, v8, v9, s89
s_mov_b32 s60, 0x07060503
s_mov_b32 s61, 0x07060502
s_mov_b32 s62, 0x07060501
s_mov_b32 s63, 0x04000c0c
s_mov_b32 s64, 0x0706000c
s_cmp_lg_u32 s42, 0
s_cbranch_scc1 L_noinit
v_mov_b32 v8, 14112
v_mov_b32 v10, 0
v_mov_b32 v11, 0
v_mov_b32 v12, 0
v_mov_b32 v13, 0
ds_write_b128 v8, v[10:13]
ds_write_b128 v8, v[10:13] offset:16
v_mov_b32 v8, 17888
ds_write_b32 v8, v10
v_lshlrev_b32 v8, 2, v0
v_mov_b32 v9, -1
ds_write_b32 v8, v9 offset:17920
ds_write_b32 v8, v9 offset:18176
L_noinit:
s_waitcnt lgkmcnt(0)
s_mov_b32 s52, s34
s_mov_b32 s53, s35
s_mov_b32 s54, 2097152
s_mov_b32 s55, 0x20000
s_mov_b32 s44, s8
s_mov_b32 s45, s9
s_mov_b32 s46, 1792
s_mov_b32 s47, 0x20000
s_mov_b32 s48, s26
s_mov_b32 s49, s27
s_mov_b32 s50, 1792
s_mov_b32 s51, 0x20000
v_mov_b32 v10, 0
buffer_load_dword v11, v10, s[52:55], 0 offen sc1
v_lshlrev_b32 v12, 4, v0
v_cmp_gt_u32 vcc, 56, v0
v_mov_b32 v13, 0x10000000
s_nop 0
v_cndmask_b32 v12, v13, v12, vcc
s_cmp_eq_u32 s39, 3
s_cbranch_scc1 L_roleP
s_cmp_eq_u32 s39, 7
s_cbranch_scc1 L_roleP
s_cmp_lt_u32 s38, 14
s_cselect_b32 s66, 6, 8
s_cmp_eq_u32 s39, s66
s_cbranch_scc0 L_nom1only_13
s_lshl_b32 s67, s38, 8
s_add_u32 s67, s67, 237568
v_and_b32 v8, 3, v0
v_lshrrev_b32 v9, 1, v8
v_mul_u32_u24 v9, 10752, v9
v_and_b32 v8, 1, v8
v_lshlrev_b32 v8, 7, v8
v_add_u32 v8, v8, v9
buffer_load_dword v20, v8, s[52:55], s67 offen sc1
buffer_load_dwordx4 v[24:27], v12, s[48:51], 0 offen nt
buffer_load_dwordx4 v[28:31], v12, s[48:51], 0 offen offset:896 nt
s_lshl_b32 s67, s38, 7
v_lshrrev_b32 v8, 3, v0
v_mul_u32_u24 v8, 5376, v8
v_and_b32 v10, 7, v0
v_lshlrev_b32 v10, 4, v10
s_mul_i32 s66, s42, 602112
s_add_u32 s66, s66, s67
v_add3_u32 v8, v8, v10, s66
s_mul_i32 s70, s42, 14336
s_add_u32 s70, s70, 18432
s_mov_b32 s82, s28
s_mov_b32 s83, s29
s_add_u32 m0, s70, 0
s_nop 0
global_load_lds_dwordx4 v8, s[82:83] nt
s_add_u32 s82, s82, 43008
s_addc_u32 s83, s83, 0
s_add_u32 m0, s70, 1024
s_nop 0
global_load_lds_dwordx4 v8, s[82:83] nt
s_add_u32 s82, s82, 43008
s_addc_u32 s83, s83, 0
s_add_u32 m0, s70, 2048
s_nop 0
global_load_lds_dwordx4 v8, s[82:83] nt
s_add_u32 s82, s82, 43008
s_addc_u32 s83, s83, 0
s_add_u32 m0, s70, 3072
s_nop 0
global_load_lds_dwordx4 v8, s[82:83] nt
s_add_u32 s82, s82, 43008
s_addc_u32 s83, s83, 0
s_add_u32 m0, s70, 4096
s_nop 0
global_load_lds_dwordx4 v8, s[82:83] nt
s_add_u32 s82, s82, 43008
s_addc_u32 s83, s83, 0
s_add_u32 m0, s70, 5120
s_nop 0
global_load_lds_dwordx4 v8, s[82:83] nt
s_add_u32 s82, s82, 43008
s_addc_u32 s83, s83, 0
s_add_u32 m0, s70, 6144
s_nop 0
global_load_lds_dwordx4 v8, s[82:83] nt
s_add_u32 s82, s82, 43008
s_addc_u32 s83, s83, 0
s_add_u32 m0, s70, 7168
s_nop 0
global_load_lds_dwordx4 v8, s[82:83] nt
s_add_u32 s82, s82, 43008
s_addc_u32 s83, s83, 0
s_add_u32 m0, s70, 8192
s_nop 0
global_load_lds_dwordx4 v8, s[82:83] nt
s_add_u32 s82, s82, 43008
s_addc_u32 s83, s83, 0
s_add_u32 m0, s70, 9216
s_nop 0
global_load_lds_dwordx4 v8, s[82:83] nt
s_add_u32 s82, s82, 43008
s_addc_u32 s83, s83, 0
s_add_u32 m0, s70, 10240
s_nop 0
global_load_lds_dwordx4 v8, s[82:83] nt
s_add_u32 s82, s82, 43008
s_addc_u32 s83, s83, 0
s_add_u32 m0, s70, 11264
s_nop 0
global_load_lds_dwordx4 v8, s[82:83] nt
s_add_u32 s82, s82, 43008
s_addc_u32 s83, s83, 0
s_add_u32 m0, s70, 12288
s_nop 0
global_load_lds_dwordx4 v8, s[82:83] nt
s_add_u32 s82, s82, 43008
s_addc_u32 s83, s83, 0
s_add_u32 m0, s70, 13312
s_nop 0
global_load_lds_dwordx4 v8, s[82:83] nt
s_barrier
s_waitcnt vmcnt(14)
v_readfirstlane_b32 s36, v11
s_mul_i32 s36, s36, 0x9E3779B1
s_add_u32 s36, s36, 0x85EBCA6B
v_lshlrev_b32 v32, 16, v24
v_and_b32 v33, 0xffff0000, v24
v_lshlrev_b32 v34, 16, v25
v_and_b32 v35, 0xffff0000, v25
v_lshlrev_b32 v36, 16, v26
v_and_b32 v37, 0xffff0000, v26
v_lshlrev_b32 v38, 16, v27
v_and_b32 v39, 0xffff0000, v27
v_lshlrev_b32 v40, 16, v28
v_and_b32 v41, 0xffff0000, v28
v_lshlrev_b32 v42, 16, v29
v_and_b32 v43, 0xffff0000, v29
v_lshlrev_b32 v44, 16, v30
v_and_b32 v45, 0xffff0000, v30
v_lshlrev_b32 v46, 16, v31
v_and_b32 v47, 0xffff0000, v31
v_mul_f32 v48, 0xbfb8aa3b, v32
v_mul_f32 v49, 0xbfb8aa3b, v33
v_mul_f32 v50, 0xbfb8aa3b, v34
v_mul_f32 v51, 0xbfb8aa3b, v35
v_mul_f32 v52, 0xbfb8aa3b, v36
v_mul_f32 v53, 0xbfb8aa3b, v37
v_mul_f32 v54, 0xbfb8aa3b, v38
v_mul_f32 v55, 0xbfb8aa3b, v39
v_mul_f32 v56, 0xbfb8aa3b, v40
v_mul_f32 v57, 0xbfb8aa3b, v41
v_mul_f32 v58, 0xbfb8aa3b, v42
v_mul_f32 v59, 0xbfb8aa3b, v43
v_mul_f32 v60, 0xbfb8aa3b, v44
v_mul_f32 v61, 0xbfb8aa3b, v45
v_mul_f32 v62, 0xbfb8aa3b, v46
v_mul_f32 v63, 0xbfb8aa3b, v47
v_exp_f32 v48, v48
v_exp_f32 v49, v49
v_exp_f32 v50, v50
v_exp_f32 v51, v51
v_exp_f32 v52, v52
v_exp_f32 v53, v53
v_exp_f32 v54, v54
v_exp_f32 v55, v55
v_exp_f32 v56, v56
v_exp_f32 v57, v57
v_exp_f32 v58, v58
v_exp_f32 v59, v59
v_exp_f32 v60, v60
v_exp_f32 v61, v61
v_exp_f32 v62, v62
v_exp_f32 v63, v63
v_add_f32 v48, 1.0, v48
v_add_f32 v49, 1.0, v49
v_add_f32 v50, 1.0, v50
v_add_f32 v51, 1.0, v51
v_add_f32 v52, 1.0, v52
v_add_f32 v53, 1.0, v53
v_add_f32 v54, 1.0, v54
v_add_f32 v55, 1.0, v55
v_add_f32 v56, 1.0, v56
v_add_f32 v57, 1.0, v57
v_add_f32 v58, 1.0, v58
v_add_f32 v59, 1.0, v59
v_add_f32 v60, 1.0, v60
v_add_f32 v61, 1.0, v61
v_add_f32 v62, 1.0, v62
v_add_f32 v63, 1.0, v63
v_rcp_f32 v48, v48
v_rcp_f32 v49, v49
v_rcp_f32 v50, v50
v_rcp_f32 v51, v51
v_rcp_f32 v52, v52
v_rcp_f32 v53, v53
v_rcp_f32 v54, v54
v_rcp_f32 v55, v55
v_rcp_f32 v56, v56
v_rcp_f32 v57, v57
v_rcp_f32 v58, v58
v_rcp_f32 v59, v59
v_rcp_f32 v60, v60
v_rcp_f32 v61, v61
v_rcp_f32 v62, v62
v_rcp_f32 v63, v63
v_mul_f32 v32, v32, v48
v_mul_f32 v33, v33, v49
v_mul_f32 v34, v34, v50
v_mul_f32 v35, v35, v51
v_mul_f32 v36, v36, v52
v_mul_f32 v37, v37, v53
v_mul_f32 v38, v38, v54
v_mul_f32 v39, v39, v55
v_mul_f32 v40, v40, v56
v_mul_f32 v41, v41, v57
v_mul_f32 v42, v42, v58
v_mul_f32 v43, v43, v59
v_mul_f32 v44, v44, v60
v_mul_f32 v45, v45, v61
v_mul_f32 v46, v46, v62
v_mul_f32 v47, v47, v63
v_cvt_pk_bf16_f32 v48, v32, v33
v_cvt_pk_bf16_f32 v49, v34, v35
v_cvt_pk_bf16_f32 v50, v36, v37
v_cvt_pk_bf16_f32 v51, v38, v39
v_cvt_pk_bf16_f32 v52, v40, v41
v_cvt_pk_bf16_f32 v53, v42, v43
v_cvt_pk_bf16_f32 v54, v44, v45
v_cvt_pk_bf16_f32 v55, v46, v47
v_lshlrev_b32 v8, 4, v0
v_add_u32 v8, s89, v8
s_mov_b32 exec_lo, 0xffffffff
s_mov_b32 exec_hi, 0xffffff
ds_write_b128 v8, v[48:51]
ds_write_b128 v8, v[52:55] offset:896
s_mov_b64 exec, -1
s_waitcnt lgkmcnt(0)
ds_read_b128 v[64:67], v4 offset:0
ds_read_b128 v[68:71], v4 offset:64
ds_read_b128 v[72:75], v4 offset:128
ds_read_b128 v[76:79], v4 offset:192
ds_read_b128 v[80:83], v4 offset:256
ds_read_b128 v[84:87], v4 offset:320
ds_read_b128 v[88:91], v4 offset:384
ds_read_b128 v[92:95], v4 offset:448
ds_read_b128 v[96:99], v4 offset:512
ds_read_b128 v[100:103], v4 offset:576
ds_read_b128 v[104:107], v4 offset:640
ds_read_b128 v[108:111], v4 offset:704
ds_read_b128 v[112:115], v4 offset:768
ds_read_b128 v[116:119], v4 offset:832
v_lshlrev_b32 v10, 7, v5
v_lshlrev_b32 v9, 3, v6
s_lshl_b32 s66, s42, 5
s_add_u32 s66, s66, 18432
v_add3_u32 v10, v10, v9, s66
s_waitcnt vmcnt(0)
s_mov_b32 exec_lo, 0x1
s_mov_b32 exec_hi, 0x0
v_mov_b32 v8, 14112
v_mov_b32 v9, 1
ds_add_u32 v8, v9
s_mov_b64 exec, -1
v_mov_b32 v8, 14112
s_mov_b32 s72, 200000
s_nop 0
L_lw_14:
ds_read_b32 v9, v8
s_waitcnt lgkmcnt(0)
v_readfirstlane_b32 s71, v9
s_cmp_ge_u32 s71, 4
s_nop 2
s_cbranch_scc1 L_lwok_15
s_sub_u32 s72, s72, 1
s_cbranch_scc0 L_lw_14
L_lwok_15:
ds_read_b64_tr_b16 v[120:121], v10 offset:0
ds_read_b64_tr_b16 v[122:123], v10 offset:512
ds_read_b64_tr_b16 v[124:125], v10 offset:4096
ds_read_b64_tr_b16 v[126:127], v10 offset:4608
ds_read_b64_tr_b16 v[128:129], v10 offset:8192
ds_read_b64_tr_b16 v[130:131], v10 offset:8704
ds_read_b64_tr_b16 v[132:133], v10 offset:12288
ds_read_b64_tr_b16 v[134:135], v10 offset:12800
ds_read_b64_tr_b16 v[136:137], v10 offset:16384
ds_read_b64_tr_b16 v[138:139], v10 offset:16896
ds_read_b64_tr_b16 v[140:141], v10 offset:20480
ds_read_b64_tr_b16 v[142:143], v10 offset:20992
ds_read_b64_tr_b16 v[144:145], v10 offset:24576
ds_read_b64_tr_b16 v[146:147], v10 offset:25088
ds_read_b64_tr_b16 v[148:149], v10 offset:28672
ds_read_b64_tr_b16 v[150:151], v10 offset:29184
ds_read_b64_tr_b16 v[152:153], v10 offset:32768
ds_read_b64_tr_b16 v[154:155], v10 offset:33280
ds_read_b64_tr_b16 v[156:157], v10 offset:36864
ds_read_b64_tr_b16 v[158:159], v10 offset:37376
ds_read_b64_tr_b16 v[160:161], v10 offset:40960
ds_read_b64_tr_b16 v[162:163], v10 offset:41472
ds_read_b64_tr_b16 v[164:165], v10 offset:45056
ds_read_b64_tr_b16 v[166:167], v10 offset:45568
ds_read_b64_tr_b16 v[168:169], v10 offset:49152
ds_read_b64_tr_b16 v[170:171], v10 offset:49664
ds_read_b64_tr_b16 v[172:173], v10 offset:53248
ds_read_b64_tr_b16 v[174:175], v10 offset:53760
s_lshl_b32 s68, s38, 8
s_lshl_b32 s67, s42, 6
s_add_u32 s68, s68, s67
s_add_u32 s68, s68, 237568
v_mul_u32_u24 v8, 10752, v2
v_lshlrev_b32 v9, 4, v3
v_add3_u32 v8, v8, v9, s68
s_waitcnt lgkmcnt(0)
v_mfma_f32_16x16x32_bf16 v[32:35], v[120:123], v[64:67], 0
v_mfma_f32_16x16x32_bf16 v[32:35], v[124:127], v[68:71], v[32:35]
v_mfma_f32_16x16x32_bf16 v[32:35], v[128:131], v[72:75], v[32:35]
v_mfma_f32_16x16x32_bf16 v[32:35], v[132:135], v[76:79], v[32:35]
v_mfma_f32_16x16x32_bf16 v[32:35], v[136:139], v[80:83], v[32:35]
v_mfma_f32_16x16x32_bf16 v[32:35], v[140:143], v[84:87], v[32:35]
v_mfma_f32_16x16x32_bf16 v[32:35], v[144:147], v[88:91], v[32:35]
v_mfma_f32_16x16x32_bf16 v[32:35], v[148:151], v[92:95], v[32:35]
v_mfma_f32_16x16x32_bf16 v[32:35], v[152:155], v[96:99], v[32:35]
v_mfma_f32_16x16x32_bf16 v[32:35], v[156:159], v[100:103], v[32:35]
v_mfma_f32_16x16x32_bf16 v[32:35], v[160:163], v[104:107], v[32:35]
v_mfma_f32_16x16x32_bf16 v[32:35], v[164:167], v[108:111], v[32:35]
v_mfma_f32_16x16x32_bf16 v[32:35], v[168:171], v[112:115], v[32:35]
v_mfma_f32_16x16x32_bf16 v[32:35], v[172:175], v[116:119], v[32:35]
s_nop 7
v_cvt_pk_bf16_f32 v40, v32, v33
v_lshlrev_b32 v32, 16, v40
v_and_b32 v33, 0xffff0000, v40
v_cvt_pk_bf16_f32 v40, v34, v35
v_lshlrev_b32 v34, 16, v40
v_and_b32 v35, 0xffff0000, v40
v_perm_b32 v16, v32, v35, s60
v_perm_b32 v17, v33, v35, s61
v_perm_b32 v18, v34, v35, s62
v_mov_b32 v19, s36
s_mov_b32 exec_lo, 0x30003
s_mov_b32 exec_hi, 0x30003
buffer_store_dwordx4 v[16:19], v8, s[52:55], 0 offen sc1
s_mov_b64 exec, -1
s_barrier
s_branch L_qsum
L_nom1only_13:
s_barrier
s_waitcnt vmcnt(0)
v_readfirstlane_b32 s36, v11
s_mul_i32 s36, s36, 0x9E3779B1
s_add_u32 s36, s36, 0x85EBCA6B
s_cmp_lg_u32 s39, 0
s_nop 0
s_cbranch_scc1 L_noci_16
s_cmp_lg_u32 s42, 0
s_cbranch_scc1 L_noci_16
v_mov_b32 v16, 0
v_mov_b32 v17, 0
v_mov_b32 v18, 0
v_mov_b32 v19, s36
s_lshl_b32 s66, s38, 7
s_add_u32 s66, s66, 233472
s_mov_b32 exec_lo, 0x1
s_mov_b32 exec_hi, 0x0
buffer_store_dwordx4 v[16:19], off, s[52:55], s66 sc1
s_mov_b64 exec, -1
s_nop 0
L_noci_16:
s_cmp_lg_u32 s42, 0
s_cbranch_scc1 L_s2
v_mov_b32 v8, 14112
s_mov_b32 s72, 200000
s_nop 0
L_lw_17:
ds_read_b32 v9, v8
s_waitcnt lgkmcnt(0)
v_readfirstlane_b32 s71, v9
s_cmp_ge_u32 s71, 4
s_nop 2
s_cbranch_scc1 L_lwok_18
s_sleep 4
s_sub_u32 s72, s72, 1
s_cbranch_scc0 L_lw_17
L_lwok_18:
s_branch L_qsum
L_roleP:
s_cmp_eq_u32 s39, 7
s_cselect_b32 s78, 32, 0
s_add_u32 s78, s78, s38
s_mov_b32 s76, 0
L_noM1a:
s_lshl_b32 s67, s78, 8
s_add_u32 s67, s67, 4096
v_and_b32 v8, 3, v0
v_lshrrev_b32 v9, 1, v8
v_lshlrev_b32 v9, 14, v9
v_and_b32 v8, 1, v8
v_lshlrev_b32 v8, 7, v8
v_add_u32 v8, v8, v9
buffer_load_dword v20, v8, s[52:55], s67 offen sc1
buffer_load_dwordx4 v[176:179], v12, s[44:47], 0 offen nt
buffer_load_dwordx4 v[180:183], v12, s[44:47], 0 offen offset:896 nt
s_lshr_b32 s68, s42, 1
s_mul_i32 s68, s68, 896
s_and_b32 s69, s42, 1
s_mul_i32 s69, s69, 448
s_add_u32 s68, s68, s69
v_lshlrev_b32 v13, 3, v0
v_add_u32 v13, s68, v13
buffer_load_dwordx2 v[14:15], v13, s[44:47], 0 offen
s_lshl_b32 s67, s78, 7
v_lshrrev_b32 v8, 3, v0
v_mul_u32_u24 v8, 8192, v8
v_and_b32 v10, 7, v0
v_lshlrev_b32 v10, 4, v10
s_mul_i32 s66, s42, 917504
s_add_u32 s66, s66, s67
v_add3_u32 v8, v8, v10, s66
s_mul_i32 s70, s42, 14336
s_add_u32 s70, s70, 75776
s_mov_b32 s82, s14
s_mov_b32 s83, s15
s_add_u32 m0, s70, 0
s_nop 0
global_load_lds_dwordx4 v8, s[82:83] nt
s_add_u32 s82, s82, 65536
s_addc_u32 s83, s83, 0
s_add_u32 m0, s70, 1024
s_nop 0
global_load_lds_dwordx4 v8, s[82:83] nt
s_add_u32 s82, s82, 65536
s_addc_u32 s83, s83, 0
s_add_u32 m0, s70, 2048
s_nop 0
global_load_lds_dwordx4 v8, s[82:83] nt
s_add_u32 s82, s82, 65536
s_addc_u32 s83, s83, 0
s_add_u32 m0, s70, 3072
s_nop 0
global_load_lds_dwordx4 v8, s[82:83] nt
s_add_u32 s82, s82, 65536
s_addc_u32 s83, s83, 0
s_add_u32 m0, s70, 4096
s_nop 0
global_load_lds_dwordx4 v8, s[82:83] nt
s_add_u32 s82, s82, 65536
s_addc_u32 s83, s83, 0
s_add_u32 m0, s70, 5120
s_nop 0
global_load_lds_dwordx4 v8, s[82:83] nt
s_add_u32 s82, s82, 65536
s_addc_u32 s83, s83, 0
s_add_u32 m0, s70, 6144
s_nop 0
global_load_lds_dwordx4 v8, s[82:83] nt
s_add_u32 s82, s82, 65536
s_addc_u32 s83, s83, 0
s_add_u32 m0, s70, 7168
s_nop 0
global_load_lds_dwordx4 v8, s[82:83] nt
s_add_u32 s82, s82, 65536
s_addc_u32 s83, s83, 0
s_add_u32 m0, s70, 8192
s_nop 0
global_load_lds_dwordx4 v8, s[82:83] nt
s_add_u32 s82, s82, 65536
s_addc_u32 s83, s83, 0
s_add_u32 m0, s70, 9216
s_nop 0
global_load_lds_dwordx4 v8, s[82:83] nt
s_add_u32 s82, s82, 65536
s_addc_u32 s83, s83, 0
s_add_u32 m0, s70, 10240
s_nop 0
global_load_lds_dwordx4 v8, s[82:83] nt
s_add_u32 s82, s82, 65536
s_addc_u32 s83, s83, 0
s_add_u32 m0, s70, 11264
s_nop 0
global_load_lds_dwordx4 v8, s[82:83] nt
s_add_u32 s82, s82, 65536
s_addc_u32 s83, s83, 0
s_add_u32 m0, s70, 12288
s_nop 0
global_load_lds_dwordx4 v8, s[82:83] nt
s_add_u32 s82, s82, 65536
s_addc_u32 s83, s83, 0
s_add_u32 m0, s70, 13312
s_nop 0
global_load_lds_dwordx4 v8, s[82:83] nt
s_barrier
L_noM1b:
s_waitcnt vmcnt(14)
v_readfirstlane_b32 s36, v11
s_mul_i32 s36, s36, 0x9E3779B1
s_add_u32 s36, s36, 0x85EBCA6B
v_lshlrev_b32 v32, 16, v176
v_and_b32 v33, 0xffff0000, v176
v_lshlrev_b32 v34, 16, v177
v_and_b32 v35, 0xffff0000, v177
v_lshlrev_b32 v36, 16, v178
v_and_b32 v37, 0xffff0000, v178
v_lshlrev_b32 v38, 16, v179
v_and_b32 v39, 0xffff0000, v179
v_lshlrev_b32 v40, 16, v180
v_and_b32 v41, 0xffff0000, v180
v_lshlrev_b32 v42, 16, v181
v_and_b32 v43, 0xffff0000, v181
v_lshlrev_b32 v44, 16, v182
v_and_b32 v45, 0xffff0000, v182
v_lshlrev_b32 v46, 16, v183
v_and_b32 v47, 0xffff0000, v183
v_add_f32 v48, v32, v33
v_add_f32 v49, v40, v41
v_add_f32 v48, v48, v34
v_add_f32 v49, v49, v42
v_add_f32 v48, v48, v35
v_add_f32 v49, v49, v43
v_add_f32 v48, v48, v36
v_add_f32 v49, v49, v44
v_add_f32 v48, v48, v37
v_add_f32 v49, v49, v45
v_add_f32 v48, v48, v38
v_add_f32 v49, v49, v46
v_add_f32 v48, v48, v39
v_add_f32 v49, v49, v47
s_nop 0
v_add_f32_dpp v48, v48, v48 quad_perm:[1,0,3,2] row_mask:0xf bank_mask:0xf
v_add_f32_dpp v49, v49, v49 quad_perm:[1,0,3,2] row_mask:0xf bank_mask:0xf
s_nop 0
v_add_f32_dpp v48, v48, v48 quad_perm:[2,3,0,1] row_mask:0xf bank_mask:0xf
v_add_f32_dpp v49, v49, v49 quad_perm:[2,3,0,1] row_mask:0xf bank_mask:0xf
s_nop 0
v_add_f32_dpp v48, v48, v48 row_half_mirror row_mask:0xf bank_mask:0xf
v_add_f32_dpp v49, v49, v49 row_half_mirror row_mask:0xf bank_mask:0xf
s_nop 0
v_add_f32_dpp v48, v48, v48 row_mirror row_mask:0xf bank_mask:0xf
v_add_f32_dpp v49, v49, v49 row_mirror row_mask:0xf bank_mask:0xf
v_mov_b32 v50, v48
v_mov_b32 v51, v49
s_nop 0
v_permlane16_swap_b32 v48, v50
v_permlane16_swap_b32 v49, v51
v_add_f32 v48, v48, v50
v_add_f32 v49, v49, v51
v_mov_b32 v50, v48
v_mov_b32 v51, v49
s_nop 0
v_permlane32_swap_b32 v48, v50
v_permlane32_swap_b32 v49, v51
v_add_f32 v48, v48, v50
v_add_f32 v49, v49, v51
v_mul_f32 v48, 0x3b124925, v48
v_mul_f32 v49, 0x3b124925, v49
v_sub_f32 v52, v32, v48
v_sub_f32 v53, v40, v49
v_mul_f32 v50, v52, v52
v_mul_f32 v51, v53, v53
v_sub_f32 v52, v33, v48
v_sub_f32 v53, v41, v49
v_fmac_f32 v50, v52, v52
v_fmac_f32 v51, v53, v53
v_sub_f32 v52, v34, v48
v_sub_f32 v53, v42, v49
v_fmac_f32 v50, v52, v52
v_fmac_f32 v51, v53, v53
v_sub_f32 v52, v35, v48
v_sub_f32 v53, v43, v49
v_fmac_f32 v50, v52, v52
v_fmac_f32 v51, v53, v53
v_sub_f32 v52, v36, v48
v_sub_f32 v53, v44, v49
v_fmac_f32 v50, v52, v52
v_fmac_f32 v51, v53, v53
v_sub_f32 v52, v37, v48
v_sub_f32 v53, v45, v49
v_fmac_f32 v50, v52, v52
v_fmac_f32 v51, v53, v53
v_sub_f32 v52, v38, v48
v_sub_f32 v53, v46, v49
v_fmac_f32 v50, v52, v52
v_fmac_f32 v51, v53, v53
v_sub_f32 v52, v39, v48
v_sub_f32 v53, v47, v49
v_fmac_f32 v50, v52, v52
v_fmac_f32 v51, v53, v53
v_cmp_gt_u32 vcc, 56, v0
s_nop 1
v_cndmask_b32 v50, 0, v50, vcc
v_cndmask_b32 v51, 0, v51, vcc
s_nop 0
v_add_f32_dpp v50, v50, v50 quad_perm:[1,0,3,2] row_mask:0xf bank_mask:0xf
v_add_f32_dpp v51, v51, v51 quad_perm:[1,0,3,2] row_mask:0xf bank_mask:0xf
s_nop 0
v_add_f32_dpp v50, v50, v50 quad_perm:[2,3,0,1] row_mask:0xf bank_mask:0xf
v_add_f32_dpp v51, v51, v51 quad_perm:[2,3,0,1] row_mask:0xf bank_mask:0xf
s_nop 0
v_add_f32_dpp v50, v50, v50 row_half_mirror row_mask:0xf bank_mask:0xf
v_add_f32_dpp v51, v51, v51 row_half_mirror row_mask:0xf bank_mask:0xf
s_nop 0
v_add_f32_dpp v50, v50, v50 row_mirror row_mask:0xf bank_mask:0xf
v_add_f32_dpp v51, v51, v51 row_mirror row_mask:0xf bank_mask:0xf
v_mov_b32 v52, v50
v_mov_b32 v53, v51
s_nop 0
v_permlane16_swap_b32 v50, v52
v_permlane16_swap_b32 v51, v53
v_add_f32 v50, v50, v52
v_add_f32 v51, v51, v53
v_mov_b32 v52, v50
v_mov_b32 v53, v51
s_nop 0
v_permlane32_swap_b32 v50, v52
v_permlane32_swap_b32 v51, v53
v_add_f32 v50, v50, v52
v_add_f32 v51, v51, v53
v_mul_f32 v50, 0x3b124925, v50
v_mul_f32 v51, 0x3b124925, v51
v_cvt_pk_bf16_f32 v52, v50, v51
v_lshlrev_b32 v50, 16, v52
v_and_b32 v51, 0xffff0000, v52
v_add_f32 v50, 0x3727c5ac, v50
v_add_f32 v51, 0x3727c5ac, v51
v_cvt_pk_bf16_f32 v52, v50, v51
v_lshlrev_b32 v50, 16, v52
v_and_b32 v51, 0xffff0000, v52
v_sqrt_f32 v50, v50
v_sqrt_f32 v51, v51
s_nop 0
v_cvt_pk_bf16_f32 v52, v50, v51
v_lshlrev_b32 v50, 16, v52
v_and_b32 v51, 0xffff0000, v52
v_rcp_f32 v58, v50
v_rcp_f32 v59, v51
v_cvt_pk_bf16_f32 v52, v48, v49
v_lshlrev_b32 v56, 16, v52
v_and_b32 v57, 0xffff0000, v52
s_cmp_ge_u32 s42, 2
s_cbranch_scc0 L_b0
v_mov_b32 v56, v57
v_mov_b32 v58, v59
s_nop 1
L_b0:
v_lshlrev_b32 v16, 16, v14
v_and_b32 v17, 0xffff0000, v14
v_lshlrev_b32 v18, 16, v15
v_and_b32 v19, 0xffff0000, v15
s_lshr_b32 s68, s42, 1
s_mul_i32 s68, s68, 10752
s_and_b32 s69, s42, 1
s_mul_i32 s69, s69, 896
s_add_u32 s68, s68, s69
s_add_u32 s68, s68, 237568
v_lshlrev_b32 v8, 4, v0
v_add_u32 v8, s68, v8
s_mov_b32 exec_lo, 0xffffffff
s_mov_b32 exec_hi, 0xffffff
s_mov_b32 s72, 200000
s_mov_b64 s[84:85], exec
buffer_load_dwordx4 v[200:203], v8, s[52:55], 0 offen sc1
buffer_load_dwordx4 v[204:207], v8, s[52:55], 0 offen offset:1792 sc1
s_sleep 6
buffer_load_dwordx4 v[208:211], v8, s[52:55], 0 offen sc1
buffer_load_dwordx4 v[212:215], v8, s[52:55], 0 offen offset:1792 sc1
L_pp_19:
s_waitcnt vmcnt(2)
v_cmpx_eq_u32 vcc, s36, v203
v_cmpx_eq_u32 vcc, s36, v207
s_cmp_eq_u64 exec, s[84:85]
s_mov_b64 exec, s[84:85]
s_nop 1
s_cbranch_scc1 L_ppok_21
buffer_load_dwordx4 v[200:203], v8, s[52:55], 0 offen sc1
buffer_load_dwordx4 v[204:207], v8, s[52:55], 0 offen offset:1792 sc1
s_waitcnt vmcnt(2)
v_cmpx_eq_u32 vcc, s36, v211
v_cmpx_eq_u32 vcc, s36, v215
s_cmp_eq_u64 exec, s[84:85]
s_mov_b64 exec, s[84:85]
s_nop 1
s_cbranch_scc1 L_ppok_22
buffer_load_dwordx4 v[208:211], v8, s[52:55], 0 offen sc1
buffer_load_dwordx4 v[212:215], v8, s[52:55], 0 offen offset:1792 sc1
s_sub_u32 s72, s72, 1
s_cbranch_scc0 L_pp_19
L_ppok_21:
v_perm_b32 v35, v200, v201, s63
v_perm_b32 v35, v35, v202, s64
v_and_b32 v32, 0xffffff00, v200
v_and_b32 v33, 0xffffff00, v201
v_and_b32 v34, 0xffffff00, v202
v_perm_b32 v39, v204, v205, s63
v_perm_b32 v39, v39, v206, s64
v_and_b32 v36, 0xffffff00, v204
v_and_b32 v37, 0xffffff00, v205
v_and_b32 v38, 0xffffff00, v206
s_nop 0
s_branch L_ppdone_20
L_ppok_22:
v_perm_b32 v35, v208, v209, s63
v_perm_b32 v35, v35, v210, s64
v_and_b32 v32, 0xffffff00, v208
v_and_b32 v33, 0xffffff00, v209
v_and_b32 v34, 0xffffff00, v210
v_perm_b32 v39, v212, v213, s63
v_perm_b32 v39, v39, v214, s64
v_and_b32 v36, 0xffffff00, v212
v_and_b32 v37, 0xffffff00, v213
v_and_b32 v38, 0xffffff00, v214
s_nop 1
L_ppdone_20:
s_mov_b64 exec, -1
v_sub_f32 v40, v16, v56
v_sub_f32 v41, v17, v56
v_sub_f32 v42, v18, v56
v_sub_f32 v43, v19, v56
v_cvt_pk_bf16_f32 v24, v40, v41
v_lshlrev_b32 v40, 16, v24
v_and_b32 v41, 0xffff0000, v24
v_cvt_pk_bf16_f32 v24, v42, v43
v_lshlrev_b32 v42, 16, v24
v_and_b32 v43, 0xffff0000, v24
v_mul_f32 v40, v40, v58
v_mul_f32 v41, v41, v58
v_mul_f32 v42, v42, v58
v_mul_f32 v43, v43, v58
v_cvt_pk_bf16_f32 v24, v40, v41
v_lshlrev_b32 v40, 16, v24
v_and_b32 v41, 0xffff0000, v24
v_cvt_pk_bf16_f32 v24, v42, v43
v_lshlrev_b32 v42, 16, v24
v_and_b32 v43, 0xffff0000, v24
v_add_f32 v36, 1.0, v36
v_add_f32 v37, 1.0, v37
v_add_f32 v38, 1.0, v38
v_add_f32 v39, 1.0, v39
v_cvt_pk_bf16_f32 v24, v36, v37
v_lshlrev_b32 v36, 16, v24
v_and_b32 v37, 0xffff0000, v24
v_cvt_pk_bf16_f32 v24, v38, v39
v_lshlrev_b32 v38, 16, v24
v_and_b32 v39, 0xffff0000, v24
v_mul_f32 v40, v40, v36
v_mul_f32 v41, v41, v37
v_mul_f32 v42, v42, v38
v_mul_f32 v43, v43, v39
v_cvt_pk_bf16_f32 v24, v40, v41
v_lshlrev_b32 v40, 16, v24
v_and_b32 v41, 0xffff0000, v24
v_cvt_pk_bf16_f32 v24, v42, v43
v_lshlrev_b32 v42, 16, v24
v_and_b32 v43, 0xffff0000, v24
v_add_f32 v40, v40, v32
v_add_f32 v41, v41, v33
v_add_f32 v42, v42, v34
v_add_f32 v43, v43, v35
v_cvt_pk_bf16_f32 v24, v40, v41
v_cvt_pk_bf16_f32 v25, v42, v43
s_mov_b32 exec_lo, 0xffffffff
s_mov_b32 exec_hi, 0xffffff
ds_write_b64 v13, v[24:25] offset:7168
s_mov_b64 exec, -1
v_lshlrev_b32 v10, 7, v5
v_lshlrev_b32 v9, 3, v6
s_lshl_b32 s66, s42, 5
s_add_u32 s66, s66, 75776
v_add3_u32 v10, v10, v9, s66
s_lshl_b32 s68, s78, 8
s_lshl_b32 s67, s42, 6
s_add_u32 s68, s68, s67
s_add_u32 s68, s68, 4096
v_lshlrev_b32 v11, 14, v2
v_lshlrev_b32 v9, 4, v3
v_add3_u32 v11, v11, v9, s68
v_subrev_u32 v7, s89, v4
s_waitcnt vmcnt(0) lgkmcnt(0)
s_mov_b32 exec_lo, 0x1
s_mov_b32 exec_hi, 0x0
v_mov_b32 v8, 14116
v_mov_b32 v9, 1
ds_add_u32 v8, v9
s_mov_b64 exec, -1
v_mov_b32 v8, 14116
s_mov_b32 s72, 200000
s_nop 0
L_lw_23:
ds_read_b32 v9, v8
s_waitcnt lgkmcnt(0)
v_readfirstlane_b32 s71, v9
s_cmp_ge_u32 s71, 4
s_nop 2
s_cbranch_scc1 L_lwok_24
s_sub_u32 s72, s72, 1
s_cbranch_scc0 L_lw_23
L_lwok_24:
ds_read_b128 v[64:67], v7 offset:7168
ds_read_b128 v[68:71], v7 offset:7232
ds_read_b128 v[72:75], v7 offset:7296
ds_read_b128 v[76:79], v7 offset:7360
ds_read_b128 v[80:83], v7 offset:7424
ds_read_b128 v[84:87], v7 offset:7488
ds_read_b128 v[88:91], v7 offset:7552
ds_read_b128 v[92:95], v7 offset:7616
ds_read_b128 v[96:99], v7 offset:7680
ds_read_b128 v[100:103], v7 offset:7744
ds_read_b128 v[104:107], v7 offset:7808
ds_read_b128 v[108:111], v7 offset:7872
ds_read_b128 v[112:115], v7 offset:7936
ds_read_b128 v[116:119], v7 offset:8000
ds_read_b64_tr_b16 v[120:121], v10 offset:0
ds_read_b64_tr_b16 v[122:123], v10 offset:512
ds_read_b64_tr_b16 v[124:125], v10 offset:4096
ds_read_b64_tr_b16 v[126:127], v10 offset:4608
ds_read_b64_tr_b16 v[128:129], v10 offset:8192
ds_read_b64_tr_b16 v[130:131], v10 offset:8704
ds_read_b64_tr_b16 v[132:133], v10 offset:12288
ds_read_b64_tr_b16 v[134:135], v10 offset:12800
ds_read_b64_tr_b16 v[136:137], v10 offset:16384
ds_read_b64_tr_b16 v[138:139], v10 offset:16896
ds_read_b64_tr_b16 v[140:141], v10 offset:20480
ds_read_b64_tr_b16 v[142:143], v10 offset:20992
ds_read_b64_tr_b16 v[144:145], v10 offset:24576
ds_read_b64_tr_b16 v[146:147], v10 offset:25088
ds_read_b64_tr_b16 v[148:149], v10 offset:28672
ds_read_b64_tr_b16 v[150:151], v10 offset:29184
ds_read_b64_tr_b16 v[152:153], v10 offset:32768
ds_read_b64_tr_b16 v[154:155], v10 offset:33280
ds_read_b64_tr_b16 v[156:157], v10 offset:36864
ds_read_b64_tr_b16 v[158:159], v10 offset:37376
ds_read_b64_tr_b16 v[160:161], v10 offset:40960
ds_read_b64_tr_b16 v[162:163], v10 offset:41472
ds_read_b64_tr_b16 v[164:165], v10 offset:45056
ds_read_b64_tr_b16 v[166:167], v10 offset:45568
ds_read_b64_tr_b16 v[168:169], v10 offset:49152
ds_read_b64_tr_b16 v[170:171], v10 offset:49664
ds_read_b64_tr_b16 v[172:173], v10 offset:53248
ds_read_b64_tr_b16 v[174:175], v10 offset:53760
s_waitcnt lgkmcnt(0)
v_mfma_f32_16x16x32_bf16 v[32:35], v[120:123], v[64:67], 0
v_mfma_f32_16x16x32_bf16 v[32:35], v[124:127], v[68:71], v[32:35]
v_mfma_f32_16x16x32_bf16 v[32:35], v[128:131], v[72:75], v[32:35]
v_mfma_f32_16x16x32_bf16 v[32:35], v[132:135], v[76:79], v[32:35]
v_mfma_f32_16x16x32_bf16 v[32:35], v[136:139], v[80:83], v[32:35]
v_mfma_f32_16x16x32_bf16 v[32:35], v[140:143], v[84:87], v[32:35]
v_mfma_f32_16x16x32_bf16 v[32:35], v[144:147], v[88:91], v[32:35]
v_mfma_f32_16x16x32_bf16 v[32:35], v[148:151], v[92:95], v[32:35]
v_mfma_f32_16x16x32_bf16 v[32:35], v[152:155], v[96:99], v[32:35]
v_mfma_f32_16x16x32_bf16 v[32:35], v[156:159], v[100:103], v[32:35]
v_mfma_f32_16x16x32_bf16 v[32:35], v[160:163], v[104:107], v[32:35]
v_mfma_f32_16x16x32_bf16 v[32:35], v[164:167], v[108:111], v[32:35]
v_mfma_f32_16x16x32_bf16 v[32:35], v[168:171], v[112:115], v[32:35]
v_mfma_f32_16x16x32_bf16 v[32:35], v[172:175], v[116:119], v[32:35]
s_nop 7
v_cvt_pk_bf16_f32 v40, v32, v33
v_lshlrev_b32 v32, 16, v40
v_and_b32 v33, 0xffff0000, v40
v_cvt_pk_bf16_f32 v40, v34, v35
v_lshlrev_b32 v34, 16, v40
v_and_b32 v35, 0xffff0000, v40
v_perm_b32 v16, v32, v35, s60
v_perm_b32 v17, v33, v35, s61
v_perm_b32 v18, v34, v35, s62
v_mov_b32 v19, s36
s_mov_b32 exec_lo, 0x30003
s_mov_b32 exec_hi, 0x30003
buffer_store_dwordx4 v[16:19], v11, s[52:55], 0 offen sc1
s_mov_b64 exec, -1
s_barrier
L_qsum:
s_cmp_lg_u32 s42, 0
s_cbranch_scc1 L_s2
s_lshl_b32 s66, s40, 14
s_lshl_b32 s67, s41, 10
s_add_u32 s66, s66, s67
s_add_u32 s66, s66, 4096
v_lshlrev_b32 v8, 4, v0
v_add_u32 v8, s66, v8
s_lshl_b32 s68, s38, 7
s_add_u32 s68, s68, 233472
s_mov_b32 s72, 200000
s_mov_b64 s[84:85], exec
buffer_load_dwordx4 v[200:203], v8, s[52:55], 0 offen sc1
buffer_load_dwordx4 v[204:207], off, s[52:55], s68 sc1
s_sleep 8
buffer_load_dwordx4 v[208:211], v8, s[52:55], 0 offen sc1
buffer_load_dwordx4 v[212:215], off, s[52:55], s68 sc1
L_pp_25:
s_waitcnt vmcnt(2)
v_cmpx_eq_u32 vcc, s36, v203
v_cmpx_eq_u32 vcc, s36, v207
s_cmp_eq_u64 exec, s[84:85]
s_mov_b64 exec, s[84:85]
s_nop 1
s_cbranch_scc1 L_ppok_27
s_sleep 8
buffer_load_dwordx4 v[200:203], v8, s[52:55], 0 offen sc1
buffer_load_dwordx4 v[204:207], off, s[52:55], s68 sc1
s_waitcnt vmcnt(2)
v_cmpx_eq_u32 vcc, s36, v211
v_cmpx_eq_u32 vcc, s36, v215
s_cmp_eq_u64 exec, s[84:85]
s_mov_b64 exec, s[84:85]
s_nop 1
s_cbranch_scc1 L_ppok_28
s_sleep 8
buffer_load_dwordx4 v[208:211], v8, s[52:55], 0 offen sc1
buffer_load_dwordx4 v[212:215], off, s[52:55], s68 sc1
s_sub_u32 s72, s72, 1
s_cbranch_scc0 L_pp_25
L_ppok_27:
v_perm_b32 v19, v200, v201, s63
v_perm_b32 v19, v19, v202, s64
v_and_b32 v16, 0xffffff00, v200
v_and_b32 v17, 0xffffff00, v201
v_and_b32 v18, 0xffffff00, v202
v_cvt_pk_bf16_f32 v16, v16, v17
v_cvt_pk_bf16_f32 v17, v18, v19
v_lshlrev_b32 v9, 3, v0
ds_write_b64 v9, v[16:17] offset:8960
s_branch L_ppdone_26
L_ppok_28:
v_perm_b32 v19, v208, v209, s63
v_perm_b32 v19, v19, v210, s64
v_and_b32 v16, 0xffffff00, v208
v_and_b32 v17, 0xffffff00, v209
v_and_b32 v18, 0xffffff00, v210
v_cvt_pk_bf16_f32 v16, v16, v17
v_cvt_pk_bf16_f32 v17, v18, v19
v_lshlrev_b32 v9, 3, v0
ds_write_b64 v9, v[16:17] offset:8960
s_nop 0
L_ppdone_26:
s_waitcnt lgkmcnt(0)
L_s2:
s_barrier
s_mov_b32 s76, 0
s_mov_b32 s77, s38
s_cmp_eq_u32 s39, 1
s_cselect_b32 s76, 2, 0
s_cmp_eq_u32 s39, 5
s_cselect_b32 s76, 1, s76
s_cselect_b32 s66, 28, 0
s_add_u32 s77, s77, s66
s_cmp_lt_u32 s38, 28
s_cselect_b32 s76, s76, 0
s_cmp_lg_u32 s42, 0
s_cbranch_scc1 L_notouch_29
s_lshl_b32 s66, s38, 3
s_add_u32 s66, s66, s39
s_mul_i32 s67, s66, 1152
s_add_u32 s67, s67, 262144
v_min_u32 v8, 8, v0
v_lshlrev_b32 v8, 7, v8
buffer_load_dword v16, v8, s[52:55], s67 offen sc1
s_mul_i32 s67, s38, 1792
s_lshl_b32 s68, s39, 8
s_add_u32 s67, s67, s68
s_add_u32 s67, s67, 557056
v_min_u32 v8, 1, v0
v_lshlrev_b32 v8, 7, v8
buffer_load_dword v17, v8, s[52:55], s67 offen sc1
s_cmp_eq_u32 s76, 0
s_cbranch_scc1 L_notouch_29
s_mul_i32 s67, s77, 3584
s_add_u32 s67, s67, 614400
v_min_u32 v8, 27, v0
v_lshlrev_b32 v8, 7, v8
buffer_load_dword v18, v8, s[52:55], s67 offen sc1
s_mov_b32 s48, s30
s_mov_b32 s49, s31
s_mov_b32 s50, 1792
s_mov_b32 s51, 0x20000
v_lshlrev_b32 v8, 5, v0
buffer_load_dword v19, v8, s[48:51], 0 offen
s_nop 0
L_notouch_29:
s_cmp_eq_u32 s39, 7
s_cbranch_scc0 L_bgq
s_cmp_lt_u32 s38, 28
s_cbranch_scc0 L_s3
v_mov_b32 v12, 14124
s_mov_b32 s72, 200000
s_nop 0
L_lw_30:
ds_read_b32 v13, v12
s_waitcnt lgkmcnt(0)
v_readfirstlane_b32 s71, v13
s_cmp_ge_u32 s71, 4
s_nop 2
s_cbranch_scc1 L_lwok_31
s_sleep 8
s_sub_u32 s72, s72, 1
s_cbranch_scc0 L_lw_30
L_lwok_31:
v_lshlrev_b32 v12, 4, v0
v_cmp_gt_u32 vcc, 56, v0
v_mov_b32 v13, 0x10000000
s_nop 0
v_cndmask_b32 v12, v13, v12, vcc
buffer_load_dwordx4 v[24:27], v12, s[48:51], 0 offen nt
buffer_load_dwordx4 v[28:31], v12, s[48:51], 0 offen offset:896 nt
s_lshl_b32 s67, s38, 7
s_add_u32 s67, s67, 1792
v_lshrrev_b32 v8, 3, v0
v_mul_u32_u24 v8, 5376, v8
v_and_b32 v10, 7, v0
v_lshlrev_b32 v10, 4, v10
s_mul_i32 s66, s42, 602112
s_add_u32 s66, s66, s67
v_add3_u32 v8, v8, v10, s66
s_mul_i32 s70, s42, 14336
s_add_u32 s70, s70, 18432
s_mov_b32 s82, s28
s_mov_b32 s83, s29
s_add_u32 m0, s70, 0
s_nop 0
global_load_lds_dwordx4 v8, s[82:83] nt
s_add_u32 s82, s82, 43008
s_addc_u32 s83, s83, 0
s_add_u32 m0, s70, 1024
s_nop 0
global_load_lds_dwordx4 v8, s[82:83] nt
s_add_u32 s82, s82, 43008
s_addc_u32 s83, s83, 0
s_add_u32 m0, s70, 2048
s_nop 0
global_load_lds_dwordx4 v8, s[82:83] nt
s_add_u32 s82, s82, 43008
s_addc_u32 s83, s83, 0
s_add_u32 m0, s70, 3072
s_nop 0
global_load_lds_dwordx4 v8, s[82:83] nt
s_add_u32 s82, s82, 43008
s_addc_u32 s83, s83, 0
s_add_u32 m0, s70, 4096
s_nop 0
global_load_lds_dwordx4 v8, s[82:83] nt
s_add_u32 s82, s82, 43008
s_addc_u32 s83, s83, 0
s_add_u32 m0, s70, 5120
s_nop 0
global_load_lds_dwordx4 v8, s[82:83] nt
s_add_u32 s82, s82, 43008
s_addc_u32 s83, s83, 0
s_add_u32 m0, s70, 6144
s_nop 0
global_load_lds_dwordx4 v8, s[82:83] nt
s_add_u32 s82, s82, 43008
s_addc_u32 s83, s83, 0
s_add_u32 m0, s70, 7168
s_nop 0
global_load_lds_dwordx4 v8, s[82:83] nt
s_add_u32 s82, s82, 43008
s_addc_u32 s83, s83, 0
s_add_u32 m0, s70, 8192
s_nop 0
global_load_lds_dwordx4 v8, s[82:83] nt
s_add_u32 s82, s82, 43008
s_addc_u32 s83, s83, 0
s_add_u32 m0, s70, 9216
s_nop 0
global_load_lds_dwordx4 v8, s[82:83] nt
s_add_u32 s82, s82, 43008
s_addc_u32 s83, s83, 0
s_add_u32 m0, s70, 10240
s_nop 0
global_load_lds_dwordx4 v8, s[82:83] nt
s_add_u32 s82, s82, 43008
s_addc_u32 s83, s83, 0
s_add_u32 m0, s70, 11264
s_nop 0
global_load_lds_dwordx4 v8, s[82:83] nt
s_add_u32 s82, s82, 43008
s_addc_u32 s83, s83, 0
s_add_u32 m0, s70, 12288
s_nop 0
global_load_lds_dwordx4 v8, s[82:83] nt
s_add_u32 s82, s82, 43008
s_addc_u32 s83, s83, 0
s_add_u32 m0, s70, 13312
s_nop 0
global_load_lds_dwordx4 v8, s[82:83] nt
s_waitcnt vmcnt(14)
v_lshlrev_b32 v32, 16, v24
v_and_b32 v33, 0xffff0000, v24
v_lshlrev_b32 v34, 16, v25
v_and_b32 v35, 0xffff0000, v25
v_lshlrev_b32 v36, 16, v26
v_and_b32 v37, 0xffff0000, v26
v_lshlrev_b32 v38, 16, v27
v_and_b32 v39, 0xffff0000, v27
v_lshlrev_b32 v40, 16, v28
v_and_b32 v41, 0xffff0000, v28
v_lshlrev_b32 v42, 16, v29
v_and_b32 v43, 0xffff0000, v29
v_lshlrev_b32 v44, 16, v30
v_and_b32 v45, 0xffff0000, v30
v_lshlrev_b32 v46, 16, v31
v_and_b32 v47, 0xffff0000, v31
v_mul_f32 v48, 0xbfb8aa3b, v32
v_mul_f32 v49, 0xbfb8aa3b, v33
v_mul_f32 v50, 0xbfb8aa3b, v34
v_mul_f32 v51, 0xbfb8aa3b, v35
v_mul_f32 v52, 0xbfb8aa3b, v36
v_mul_f32 v53, 0xbfb8aa3b, v37
v_mul_f32 v54, 0xbfb8aa3b, v38
v_mul_f32 v55, 0xbfb8aa3b, v39
v_mul_f32 v56, 0xbfb8aa3b, v40
v_mul_f32 v57, 0xbfb8aa3b, v41
v_mul_f32 v58, 0xbfb8aa3b, v42
v_mul_f32 v59, 0xbfb8aa3b, v43
v_mul_f32 v60, 0xbfb8aa3b, v44
v_mul_f32 v61, 0xbfb8aa3b, v45
v_mul_f32 v62, 0xbfb8aa3b, v46
v_mul_f32 v63, 0xbfb8aa3b, v47
v_exp_f32 v48, v48
v_exp_f32 v49, v49
v_exp_f32 v50, v50
v_exp_f32 v51, v51
v_exp_f32 v52, v52
v_exp_f32 v53, v53
v_exp_f32 v54, v54
v_exp_f32 v55, v55
v_exp_f32 v56, v56
v_exp_f32 v57, v57
v_exp_f32 v58, v58
v_exp_f32 v59, v59
v_exp_f32 v60, v60
v_exp_f32 v61, v61
v_exp_f32 v62, v62
v_exp_f32 v63, v63
v_add_f32 v48, 1.0, v48
v_add_f32 v49, 1.0, v49
v_add_f32 v50, 1.0, v50
v_add_f32 v51, 1.0, v51
v_add_f32 v52, 1.0, v52
v_add_f32 v53, 1.0, v53
v_add_f32 v54, 1.0, v54
v_add_f32 v55, 1.0, v55
v_add_f32 v56, 1.0, v56
v_add_f32 v57, 1.0, v57
v_add_f32 v58, 1.0, v58
v_add_f32 v59, 1.0, v59
v_add_f32 v60, 1.0, v60
v_add_f32 v61, 1.0, v61
v_add_f32 v62, 1.0, v62
v_add_f32 v63, 1.0, v63
v_rcp_f32 v48, v48
v_rcp_f32 v49, v49
v_rcp_f32 v50, v50
v_rcp_f32 v51, v51
v_rcp_f32 v52, v52
v_rcp_f32 v53, v53
v_rcp_f32 v54, v54
v_rcp_f32 v55, v55
v_rcp_f32 v56, v56
v_rcp_f32 v57, v57
v_rcp_f32 v58, v58
v_rcp_f32 v59, v59
v_rcp_f32 v60, v60
v_rcp_f32 v61, v61
v_rcp_f32 v62, v62
v_rcp_f32 v63, v63
v_mul_f32 v32, v32, v48
v_mul_f32 v33, v33, v49
v_mul_f32 v34, v34, v50
v_mul_f32 v35, v35, v51
v_mul_f32 v36, v36, v52
v_mul_f32 v37, v37, v53
v_mul_f32 v38, v38, v54
v_mul_f32 v39, v39, v55
v_mul_f32 v40, v40, v56
v_mul_f32 v41, v41, v57
v_mul_f32 v42, v42, v58
v_mul_f32 v43, v43, v59
v_mul_f32 v44, v44, v60
v_mul_f32 v45, v45, v61
v_mul_f32 v46, v46, v62
v_mul_f32 v47, v47, v63
v_cvt_pk_bf16_f32 v48, v32, v33
v_cvt_pk_bf16_f32 v49, v34, v35
v_cvt_pk_bf16_f32 v50, v36, v37
v_cvt_pk_bf16_f32 v51, v38, v39
v_cvt_pk_bf16_f32 v52, v40, v41
v_cvt_pk_bf16_f32 v53, v42, v43
v_cvt_pk_bf16_f32 v54, v44, v45
v_cvt_pk_bf16_f32 v55, v46, v47
v_lshlrev_b32 v8, 4, v0
v_add_u32 v8, s89, v8
s_mov_b32 exec_lo, 0xffffffff
s_mov_b32 exec_hi, 0xffffff
ds_write_b128 v8, v[48:51]
ds_write_b128 v8, v[52:55] offset:896
s_mov_b64 exec, -1
s_waitcnt lgkmcnt(0)
ds_read_b128 v[64:67], v4 offset:0
ds_read_b128 v[68:71], v4 offset:64
ds_read_b128 v[72:75], v4 offset:128
ds_read_b128 v[76:79], v4 offset:192
ds_read_b128 v[80:83], v4 offset:256
ds_read_b128 v[84:87], v4 offset:320
ds_read_b128 v[88:91], v4 offset:384
ds_read_b128 v[92:95], v4 offset:448
ds_read_b128 v[96:99], v4 offset:512
ds_read_b128 v[100:103], v4 offset:576
ds_read_b128 v[104:107], v4 offset:640
ds_read_b128 v[108:111], v4 offset:704
ds_read_b128 v[112:115], v4 offset:768
ds_read_b128 v[116:119], v4 offset:832
v_lshlrev_b32 v10, 7, v5
v_lshlrev_b32 v9, 3, v6
s_lshl_b32 s66, s42, 5
s_add_u32 s66, s66, 18432
v_add3_u32 v10, v10, v9, s66
s_waitcnt vmcnt(0)
s_mov_b32 exec_lo, 0x1
s_mov_b32 exec_hi, 0x0
v_mov_b32 v8, 14112
v_mov_b32 v9, 1
ds_add_u32 v8, v9
s_mov_b64 exec, -1
v_mov_b32 v8, 14112
s_mov_b32 s72, 200000
s_nop 0
L_lw_32:
ds_read_b32 v9, v8
s_waitcnt lgkmcnt(0)
v_readfirstlane_b32 s71, v9
s_cmp_ge_u32 s71, 4
s_nop 2
s_cbranch_scc1 L_lwok_33
s_sub_u32 s72, s72, 1
s_cbranch_scc0 L_lw_32
L_lwok_33:
ds_read_b64_tr_b16 v[120:121], v10 offset:0
ds_read_b64_tr_b16 v[122:123], v10 offset:512
ds_read_b64_tr_b16 v[124:125], v10 offset:4096
ds_read_b64_tr_b16 v[126:127], v10 offset:4608
ds_read_b64_tr_b16 v[128:129], v10 offset:8192
ds_read_b64_tr_b16 v[130:131], v10 offset:8704
ds_read_b64_tr_b16 v[132:133], v10 offset:12288
ds_read_b64_tr_b16 v[134:135], v10 offset:12800
ds_read_b64_tr_b16 v[136:137], v10 offset:16384
ds_read_b64_tr_b16 v[138:139], v10 offset:16896
ds_read_b64_tr_b16 v[140:141], v10 offset:20480
ds_read_b64_tr_b16 v[142:143], v10 offset:20992
ds_read_b64_tr_b16 v[144:145], v10 offset:24576
ds_read_b64_tr_b16 v[146:147], v10 offset:25088
ds_read_b64_tr_b16 v[148:149], v10 offset:28672
ds_read_b64_tr_b16 v[150:151], v10 offset:29184
ds_read_b64_tr_b16 v[152:153], v10 offset:32768
ds_read_b64_tr_b16 v[154:155], v10 offset:33280
ds_read_b64_tr_b16 v[156:157], v10 offset:36864
ds_read_b64_tr_b16 v[158:159], v10 offset:37376
ds_read_b64_tr_b16 v[160:161], v10 offset:40960
ds_read_b64_tr_b16 v[162:163], v10 offset:41472
ds_read_b64_tr_b16 v[164:165], v10 offset:45056
ds_read_b64_tr_b16 v[166:167], v10 offset:45568
ds_read_b64_tr_b16 v[168:169], v10 offset:49152
ds_read_b64_tr_b16 v[170:171], v10 offset:49664
ds_read_b64_tr_b16 v[172:173], v10 offset:53248
ds_read_b64_tr_b16 v[174:175], v10 offset:53760
s_lshl_b32 s68, s38, 8
s_lshl_b32 s67, s42, 6
s_add_u32 s68, s68, s67
s_add_u32 s68, s68, 241152
v_mul_u32_u24 v8, 10752, v2
v_lshlrev_b32 v9, 4, v3
v_add3_u32 v8, v8, v9, s68
s_waitcnt lgkmcnt(0)
v_mfma_f32_16x16x32_bf16 v[32:35], v[120:123], v[64:67], 0
v_mfma_f32_16x16x32_bf16 v[32:35], v[124:127], v[68:71], v[32:35]
v_mfma_f32_16x16x32_bf16 v[32:35], v[128:131], v[72:75], v[32:35]
v_mfma_f32_16x16x32_bf16 v[32:35], v[132:135], v[76:79], v[32:35]
v_mfma_f32_16x16x32_bf16 v[32:35], v[136:139], v[80:83], v[32:35]
v_mfma_f32_16x16x32_bf16 v[32:35], v[140:143], v[84:87], v[32:35]
v_mfma_f32_16x16x32_bf16 v[32:35], v[144:147], v[88:91], v[32:35]
v_mfma_f32_16x16x32_bf16 v[32:35], v[148:151], v[92:95], v[32:35]
v_mfma_f32_16x16x32_bf16 v[32:35], v[152:155], v[96:99], v[32:35]
v_mfma_f32_16x16x32_bf16 v[32:35], v[156:159], v[100:103], v[32:35]
v_mfma_f32_16x16x32_bf16 v[32:35], v[160:163], v[104:107], v[32:35]
v_mfma_f32_16x16x32_bf16 v[32:35], v[164:167], v[108:111], v[32:35]
v_mfma_f32_16x16x32_bf16 v[32:35], v[168:171], v[112:115], v[32:35]
v_mfma_f32_16x16x32_bf16 v[32:35], v[172:175], v[116:119], v[32:35]
s_nop 7
v_cvt_pk_bf16_f32 v40, v32, v33
v_lshlrev_b32 v32, 16, v40
v_and_b32 v33, 0xffff0000, v40
v_cvt_pk_bf16_f32 v40, v34, v35
v_lshlrev_b32 v34, 16, v40
v_and_b32 v35, 0xffff0000, v40
v_perm_b32 v16, v32, v35, s60
v_perm_b32 v17, v33, v35, s61
v_perm_b32 v18, v34, v35, s62
v_mov_b32 v19, s36
s_mov_b32 exec_lo, 0x30003
s_mov_b32 exec_hi, 0x30003
buffer_store_dwordx4 v[16:19], v8, s[52:55], 0 offen sc1
s_mov_b64 exec, -1
s_branch L_s3
L_bgq:
v_mov_b32 v12, 14124
s_mov_b32 s72, 200000
s_nop 0
L_lw_34:
ds_read_b32 v13, v12
s_waitcnt lgkmcnt(0)
v_readfirstlane_b32 s71, v13
s_cmp_ge_u32 s71, 4
s_nop 2
s_cbranch_scc1 L_lwok_35
s_sleep 8
s_sub_u32 s72, s72, 1
s_cbranch_scc0 L_lw_34
L_lwok_35:
v_lshrrev_b32 v8, 3, v0
v_mul_u32_u24 v8, 896, v8
v_and_b32 v9, 7, v0
v_lshlrev_b32 v9, 4, v9
s_mul_i32 s66, s41, 229376
s_lshl_b32 s67, s39, 7
s_add_u32 s66, s66, s67
s_mul_i32 s67, s42, 57344
s_add_u32 s66, s66, s67
v_add3_u32 v8, v8, v9, s66
s_mul_i32 s70, s42, 8192
s_add_u32 s70, s70, 18432
s_mov_b32 s82, s16
s_mov_b32 s83, s17
s_add_u32 m0, s70, 0
s_nop 0
global_load_lds_dwordx4 v8, s[82:83]
s_add_u32 s82, s82, 7168
s_addc_u32 s83, s83, 0
s_add_u32 m0, s70, 1024
s_nop 0
global_load_lds_dwordx4 v8, s[82:83]
s_add_u32 s82, s82, 7168
s_addc_u32 s83, s83, 0
s_add_u32 m0, s70, 2048
s_nop 0
global_load_lds_dwordx4 v8, s[82:83]
s_add_u32 s82, s82, 7168
s_addc_u32 s83, s83, 0
s_add_u32 m0, s70, 3072
s_nop 0
global_load_lds_dwordx4 v8, s[82:83]
s_add_u32 s82, s82, 7168
s_addc_u32 s83, s83, 0
s_add_u32 m0, s70, 4096
s_nop 0
global_load_lds_dwordx4 v8, s[82:83]
s_add_u32 s82, s82, 7168
s_addc_u32 s83, s83, 0
s_add_u32 m0, s70, 5120
s_nop 0
global_load_lds_dwordx4 v8, s[82:83]
s_add_u32 s82, s82, 7168
s_addc_u32 s83, s83, 0
s_add_u32 m0, s70, 6144
s_nop 0
global_load_lds_dwordx4 v8, s[82:83]
s_add_u32 s82, s82, 7168
s_addc_u32 s83, s83, 0
s_add_u32 m0, s70, 7168
s_nop 0
global_load_lds_dwordx4 v8, s[82:83]
s_cmp_eq_u32 s76, 0
s_cbranch_scc1 L_bgw
v_lshlrev_b32 v8, 4, v0
s_mul_i32 s66, s77, 28672
s_mul_i32 s67, s42, 7168
s_add_u32 s66, s66, s67
v_add_u32 v8, s66, v8
s_mul_i32 s70, s42, 7168
s_add_u32 s70, s70, 51200
s_mov_b32 s82, s24
s_mov_b32 s83, s25
s_add_u32 m0, s70, 0
s_nop 0
global_load_lds_dwordx4 v8, s[82:83] nt
s_add_u32 s82, s82, 1024
s_addc_u32 s83, s83, 0
s_add_u32 m0, s70, 1024
s_nop 0
global_load_lds_dwordx4 v8, s[82:83] nt
s_add_u32 s82, s82, 1024
s_addc_u32 s83, s83, 0
s_add_u32 m0, s70, 2048
s_nop 0
global_load_lds_dwordx4 v8, s[82:83] nt
s_add_u32 s82, s82, 1024
s_addc_u32 s83, s83, 0
s_add_u32 m0, s70, 3072
s_nop 0
global_load_lds_dwordx4 v8, s[82:83] nt
s_add_u32 s82, s82, 1024
s_addc_u32 s83, s83, 0
s_add_u32 m0, s70, 4096
s_nop 0
global_load_lds_dwordx4 v8, s[82:83] nt
s_add_u32 s82, s82, 1024
s_addc_u32 s83, s83, 0
s_add_u32 m0, s70, 5120
s_nop 0
global_load_lds_dwordx4 v8, s[82:83] nt
s_add_u32 s82, s82, 1024
s_addc_u32 s83, s83, 0
s_add_u32 m0, s70, 6144
s_nop 0
global_load_lds_dwordx4 v8, s[82:83] nt
v_lshrrev_b32 v12, 3, v0
v_mul_u32_u24 v12, 3584, v12
v_and_b32 v13, 3, v0
v_lshlrev_b32 v13, 4, v13
s_mul_i32 s66, s42, 401408
s_lshl_b32 s67, s77, 6
s_add_u32 s66, s66, s67
v_add3_u32 v12, v12, v13, s66
v_bfe_u32 v13, v0, 2, 1
v_cmp_eq_u32 vcc, 1, v13
v_mov_b32 v8, s20
v_mov_b32 v13, s22
v_cndmask_b32 v8, v8, v13, vcc
v_mov_b32 v9, s21
v_mov_b32 v13, s23
v_cndmask_b32 v9, v9, v13, vcc
v_add_co_u32 v8, vcc, v8, v12
s_nop 1
v_addc_co_u32 v9, vcc, 0, v9, vcc
s_mul_i32 s70, s42, 14336
s_add_u32 s70, s70, 79872
s_add_u32 m0, s70, 0
s_nop 0
global_load_lds_dwordx4 v[8:9], off
v_add_co_u32 v8, vcc, 28672, v8
s_nop 1
v_addc_co_u32 v9, vcc, 0, v9, vcc
s_add_u32 m0, s70, 1024
s_nop 0
global_load_lds_dwordx4 v[8:9], off
v_add_co_u32 v8, vcc, 28672, v8
s_nop 1
v_addc_co_u32 v9, vcc, 0, v9, vcc
s_add_u32 m0, s70, 2048
s_nop 0
global_load_lds_dwordx4 v[8:9], off
v_add_co_u32 v8, vcc, 28672, v8
s_nop 1
v_addc_co_u32 v9, vcc, 0, v9, vcc
s_add_u32 m0, s70, 3072
s_nop 0
global_load_lds_dwordx4 v[8:9], off
v_add_co_u32 v8, vcc, 28672, v8
s_nop 1
v_addc_co_u32 v9, vcc, 0, v9, vcc
s_add_u32 m0, s70, 4096
s_nop 0
global_load_lds_dwordx4 v[8:9], off
v_add_co_u32 v8, vcc, 28672, v8
s_nop 1
v_addc_co_u32 v9, vcc, 0, v9, vcc
s_add_u32 m0, s70, 5120
s_nop 0
global_load_lds_dwordx4 v[8:9], off
v_add_co_u32 v8, vcc, 28672, v8
s_nop 1
v_addc_co_u32 v9, vcc, 0, v9, vcc
s_add_u32 m0, s70, 6144
s_nop 0
global_load_lds_dwordx4 v[8:9], off
v_add_co_u32 v8, vcc, 28672, v8
s_nop 1
v_addc_co_u32 v9, vcc, 0, v9, vcc
s_add_u32 m0, s70, 7168
s_nop 0
global_load_lds_dwordx4 v[8:9], off
v_add_co_u32 v8, vcc, 28672, v8
s_nop 1
v_addc_co_u32 v9, vcc, 0, v9, vcc
s_add_u32 m0, s70, 8192
s_nop 0
global_load_lds_dwordx4 v[8:9], off
v_add_co_u32 v8, vcc, 28672, v8
s_nop 1
v_addc_co_u32 v9, vcc, 0, v9, vcc
s_add_u32 m0, s70, 9216
s_nop 0
global_load_lds_dwordx4 v[8:9], off
v_add_co_u32 v8, vcc, 28672, v8
s_nop 1
v_addc_co_u32 v9, vcc, 0, v9, vcc
s_add_u32 m0, s70, 10240
s_nop 0
global_load_lds_dwordx4 v[8:9], off
v_add_co_u32 v8, vcc, 28672, v8
s_nop 1
v_addc_co_u32 v9, vcc, 0, v9, vcc
s_add_u32 m0, s70, 11264
s_nop 0
global_load_lds_dwordx4 v[8:9], off
v_add_co_u32 v8, vcc, 28672, v8
s_nop 1
v_addc_co_u32 v9, vcc, 0, v9, vcc
s_add_u32 m0, s70, 12288
s_nop 0
global_load_lds_dwordx4 v[8:9], off
v_add_co_u32 v8, vcc, 28672, v8
s_nop 1
v_addc_co_u32 v9, vcc, 0, v9, vcc
s_add_u32 m0, s70, 13312
s_nop 0
global_load_lds_dwordx4 v[8:9], off
s_nop 1
L_bgw:
s_waitcnt vmcnt(0)
s_mov_b32 exec_lo, 0x1
s_mov_b32 exec_hi, 0x0
v_mov_b32 v8, 14120
v_mov_b32 v9, 1
ds_add_u32 v8, v9
s_mov_b64 exec, -1
v_mov_b32 v8, 14120
s_mov_b32 s72, 200000
s_nop 0
L_lw_36:
ds_read_b32 v9, v8
s_waitcnt lgkmcnt(0)
v_readfirstlane_b32 s71, v9
s_cmp_ge_u32 s71, 4
s_nop 2
s_cbranch_scc1 L_lwok_37
s_sleep 4
s_sub_u32 s72, s72, 1
s_cbranch_scc0 L_lw_36
L_lwok_37:
v_lshlrev_b32 v10, 7, v5
v_lshlrev_b32 v9, 3, v6
s_lshl_b32 s66, s42, 5
s_add_u32 s66, s66, 18432
v_add3_u32 v10, v10, v9, s66
ds_read_b64_tr_b16 v[64:65], v10 offset:0
ds_read_b64_tr_b16 v[66:67], v10 offset:512
ds_read_b64_tr_b16 v[68:69], v10 offset:4096
ds_read_b64_tr_b16 v[70:71], v10 offset:4608
ds_read_b64_tr_b16 v[72:73], v10 offset:8192
ds_read_b64_tr_b16 v[74:75], v10 offset:8704
ds_read_b64_tr_b16 v[76:77], v10 offset:12288
ds_read_b64_tr_b16 v[78:79], v10 offset:12800
ds_read_b64_tr_b16 v[80:81], v10 offset:16384
ds_read_b64_tr_b16 v[82:83], v10 offset:16896
ds_read_b64_tr_b16 v[84:85], v10 offset:20480
ds_read_b64_tr_b16 v[86:87], v10 offset:20992
ds_read_b64_tr_b16 v[88:89], v10 offset:24576
ds_read_b64_tr_b16 v[90:91], v10 offset:25088
ds_read_b64_tr_b16 v[92:93], v10 offset:28672
ds_read_b64_tr_b16 v[94:95], v10 offset:29184
s_cmp_eq_u32 s76, 0
s_cbranch_scc1 L_s3
v_lshlrev_b32 v10, 7, v5
v_lshrrev_b32 v9, 1, v6
v_lshlrev_b32 v9, 6, v9
v_and_b32 v8, 1, v6
v_lshlrev_b32 v8, 3, v8
v_add3_u32 v10, v10, v9, v8
s_lshl_b32 s66, s42, 4
s_add_u32 s66, s66, 79872
v_add_u32 v10, s66, v10
ds_read_b64_tr_b16 v[96:97], v10 offset:0
ds_read_b64_tr_b16 v[98:99], v10 offset:512
ds_read_b64_tr_b16 v[100:101], v10 offset:4096
ds_read_b64_tr_b16 v[102:103], v10 offset:4608
ds_read_b64_tr_b16 v[104:105], v10 offset:8192
ds_read_b64_tr_b16 v[106:107], v10 offset:8704
ds_read_b64_tr_b16 v[108:109], v10 offset:12288
ds_read_b64_tr_b16 v[110:111], v10 offset:12800
ds_read_b64_tr_b16 v[112:113], v10 offset:16384
ds_read_b64_tr_b16 v[114:115], v10 offset:16896
ds_read_b64_tr_b16 v[116:117], v10 offset:20480
ds_read_b64_tr_b16 v[118:119], v10 offset:20992
ds_read_b64_tr_b16 v[120:121], v10 offset:24576
ds_read_b64_tr_b16 v[122:123], v10 offset:25088
ds_read_b64_tr_b16 v[124:125], v10 offset:28672
ds_read_b64_tr_b16 v[126:127], v10 offset:29184
ds_read_b64_tr_b16 v[128:129], v10 offset:32768
ds_read_b64_tr_b16 v[130:131], v10 offset:33280
ds_read_b64_tr_b16 v[132:133], v10 offset:36864
ds_read_b64_tr_b16 v[134:135], v10 offset:37376
ds_read_b64_tr_b16 v[136:137], v10 offset:40960
ds_read_b64_tr_b16 v[138:139], v10 offset:41472
ds_read_b64_tr_b16 v[140:141], v10 offset:45056
ds_read_b64_tr_b16 v[142:143], v10 offset:45568
ds_read_b64_tr_b16 v[144:145], v10 offset:49152
ds_read_b64_tr_b16 v[146:147], v10 offset:49664
ds_read_b64_tr_b16 v[148:149], v10 offset:53248
ds_read_b64_tr_b16 v[150:151], v10 offset:53760
v_mul_u32_u24 v10, 896, v5
v_lshlrev_b32 v9, 3, v6
s_mul_i32 s66, s42, 224
s_add_u32 s66, s66, 51200
v_add3_u32 v10, v10, v9, s66
ds_read_b64_tr_b16 v[152:153], v10 offset:0
ds_read_b64_tr_b16 v[154:155], v10 offset:3584
ds_read_b64_tr_b16 v[156:157], v10 offset:32
ds_read_b64_tr_b16 v[158:159], v10 offset:3616
ds_read_b64_tr_b16 v[160:161], v10 offset:64
ds_read_b64_tr_b16 v[162:163], v10 offset:3648
ds_read_b64_tr_b16 v[164:165], v10 offset:96
ds_read_b64_tr_b16 v[166:167], v10 offset:3680
ds_read_b64_tr_b16 v[168:169], v10 offset:128
ds_read_b64_tr_b16 v[170:171], v10 offset:3712
ds_read_b64_tr_b16 v[172:173], v10 offset:160
ds_read_b64_tr_b16 v[174:175], v10 offset:3744
ds_read_b64_tr_b16 v[176:177], v10 offset:192
ds_read_b64_tr_b16 v[178:179], v10 offset:3776
s_lshr_b32 s66, s42, 1
s_and_b32 s67, s42, 1
s_mul_i32 s68, s66, 10752
s_mul_i32 s69, s67, 896
s_add_u32 s68, s68, s69
s_add_u32 s68, s68, 241152
v_lshlrev_b32 v8, 4, v0
v_add_u32 v8, s68, v8
v_bfe_u32 v12, v0, 2, 1
v_mul_u32_u24 v12, 10752, v12
v_and_b32 v13, 3, v0
v_lshlrev_b32 v13, 4, v13
s_lshl_b32 s68, s77, 6
s_add_u32 s68, s68, 246528
s_cmp_lt_u32 s76, 2
s_cselect_b32 s68, 246528, s68
v_add3_u32 v12, v12, v13, s68
s_mul_i32 s68, s66, 896
s_mul_i32 s69, s67, 448
s_add_u32 s68, s68, s69
v_lshlrev_b32 v13, 3, v0
v_add_u32 v13, s68, v13
buffer_load_dwordx2 v[14:15], v13, s[44:47], 0 offen
s_mov_b32 exec_lo, 0xffffffff
s_mov_b32 exec_hi, 0xffffff
s_mov_b32 s72, 200000
L_poll_38:
buffer_load_dwordx4 v[16:19], v8, s[52:55], 0 offen sc1
buffer_load_dwordx4 v[20:23], v8, s[52:55], 0 offen offset:1792 sc1
buffer_load_dwordx4 v[24:27], v8, s[52:55], 0 offen offset:3584 sc1
buffer_load_dwordx4 v[28:31], v12, s[52:55], 0 offen sc1
s_waitcnt vmcnt(0)
s_mov_b64 s[74:75], 0
v_cmp_ne_u32 vcc, s36, v19
s_or_b64 s[74:75], s[74:75], vcc
v_cmp_ne_u32 vcc, s36, v23
s_or_b64 s[74:75], s[74:75], vcc
v_cmp_ne_u32 vcc, s36, v27
s_or_b64 s[74:75], s[74:75], vcc
v_cmp_ne_u32 vcc, s36, v31
s_or_b64 s[74:75], s[74:75], vcc
s_cmp_eq_u64 s[74:75], 0
s_nop 1
s_cbranch_scc1 L_pollok_39
s_sub_u32 s72, s72, 1
s_cbranch_scc1 L_pollok_39
s_sleep 64
s_branch L_poll_38
L_pollok_39:
s_mov_b64 exec, -1
v_perm_b32 v195, v16, v17, s63
v_perm_b32 v195, v195, v18, s64
v_and_b32 v192, 0xffffff00, v16
v_and_b32 v193, 0xffffff00, v17
v_and_b32 v194, 0xffffff00, v18
v_perm_b32 v191, v20, v21, s63
v_perm_b32 v191, v191, v22, s64
v_and_b32 v188, 0xffffff00, v20
v_and_b32 v189, 0xffffff00, v21
v_and_b32 v190, 0xffffff00, v22
v_perm_b32 v187, v24, v25, s63
v_perm_b32 v187, v187, v26, s64
v_and_b32 v184, 0xffffff00, v24
v_and_b32 v185, 0xffffff00, v25
v_and_b32 v186, 0xffffff00, v26
v_perm_b32 v203, v28, v29, s63
v_perm_b32 v203, v203, v30, s64
v_and_b32 v200, 0xffffff00, v28
v_and_b32 v201, 0xffffff00, v29
v_and_b32 v202, 0xffffff00, v30
v_add_f32 v184, 1.0, v184
v_add_f32 v185, 1.0, v185
v_add_f32 v186, 1.0, v186
v_add_f32 v187, 1.0, v187
v_cvt_pk_bf16_f32 v16, v184, v185
v_lshlrev_b32 v184, 16, v16
v_and_b32 v185, 0xffff0000, v16
v_cvt_pk_bf16_f32 v16, v186, v187
v_lshlrev_b32 v186, 16, v16
v_and_b32 v187, 0xffff0000, v16
v_lshlrev_b32 v196, 16, v14
v_and_b32 v197, 0xffff0000, v14
v_lshlrev_b32 v198, 16, v15
v_and_b32 v199, 0xffff0000, v15
s_nop 1
L_s3:
s_cmp_lg_u32 s42, 3
s_cbranch_scc1 L_dispx_42
s_mov_b32 s66, 0x131d181d
s_mov_b32 s67, 0x151d161b
s_cmp_lt_u32 s38, 28
s_cselect_b32 s66, s66, 0x121c1b1c
s_cselect_b32 s67, s67, 0x131c1a1a
s_lshl_b32 s68, s39, 3
s_lshr_b64 s[66:67], s[66:67], s68
s_and_b32 s66, s66, 0xff
s_mov_b32 s81, s66
s_mov_b32 s80, 2
s_lshl_b32 s69, s38, 7
s_add_u32 s69, s69, 233472
s_mov_b32 s72, 200000
v_mov_b32 v8, 0
s_nop 1
L_disp_40:
ds_read_b32 v9, v8 offset:17888
s_waitcnt lgkmcnt(0)
v_readfirstlane_b32 s67, v9
s_add_u32 s67, s67, 2
s_cmp_lt_u32 s66, s67
s_nop 1
s_cbranch_scc1 L_dispn_41
s_sleep 2
s_sub_u32 s72, s72, 1
s_cbranch_scc0 L_disp_40
s_branch L_dispx_42
L_dispn_41:
s_mov_b64 exec, 1
v_mov_b32 v10, s80
buffer_atomic_add v10, off, s[52:55], s69 sc0
s_waitcnt vmcnt(0)
s_mov_b64 exec, -1
v_readfirstlane_b32 s67, v10
s_add_u32 s70, s67, 200
s_cmp_lt_u32 s67, 56
s_cselect_b32 s70, s70, 0x1000
s_lshl_b32 s68, s66, 2
v_mov_b32 v11, s68
v_mov_b32 v12, s70
ds_write_b32 v11, v12 offset:17920
s_add_u32 s66, s66, 1
s_cmp_lt_u32 s70, 256
s_cbranch_scc0 L_dispx_42
s_add_u32 s67, s67, 1
s_cmp_eq_u32 s80, 1
s_cbranch_scc1 L_disp1_43
s_add_u32 s71, s67, 200
s_cmp_lt_u32 s67, 56
s_cselect_b32 s71, s71, 0x1000
v_mov_b32 v13, s71
ds_write_b32 v11, v13 offset:17924
s_add_u32 s66, s66, 1
s_cmp_lt_u32 s71, 256
s_cbranch_scc0 L_dispx_42
s_add_u32 s67, s67, 1
L_disp1_43:
s_cmp_ge_u32 s67, 56
s_cselect_b32 s80, 1, 2
s_branch L_disp_40
L_dispx_42:
s_waitcnt lgkmcnt(0) vmcnt(0)
s_barrier
s_cmp_lg_u32 s42, 0
s_cbranch_scc1 L_t1
v_lshlrev_b32 v8, 4, v0
ds_read_b128 v[16:19], v8 offset:9984
ds_read_b128 v[20:23], v8 offset:11008
ds_read_b128 v[24:27], v8 offset:12032
ds_read_b128 v[28:31], v8 offset:13056
v_mov_b32 v9, 14080
ds_read_b128 v[32:35], v9
ds_read_b128 v[36:39], v9 offset:16
s_lshl_b32 s66, s38, 3
s_mul_i32 s67, s66, 1152
s_add_u32 s67, s67, 262144
s_mul_i32 s68, s39, 1152
s_add_u32 s68, s68, s67
s_waitcnt lgkmcnt(0)
v_max_f32 v40, v32, v34
v_max3_f32 v40, v40, v36, v38
v_sub_f32 v44, v32, v40
v_sub_f32 v45, v34, v40
v_sub_f32 v46, v36, v40
v_sub_f32 v47, v38, v40
v_mul_f32 v44, s65, v44
v_mul_f32 v45, s65, v45
v_mul_f32 v46, s65, v46
v_mul_f32 v47, s65, v47
v_exp_f32 v44, v44
v_exp_f32 v45, v45
v_exp_f32 v46, v46
v_exp_f32 v47, v47
v_pk_mul_f32 v[48:49], v[16:17], v[44:45] op_sel_hi:[1,0]
v_pk_mul_f32 v[50:51], v[18:19], v[44:45] op_sel_hi:[1,0]
v_mul_f32 v41, v33, v44
v_pk_fma_f32 v[48:49], v[20:21], v[44:45], v[48:49] op_sel:[0,1,0] op_sel_hi:[1,1,1]
v_pk_fma_f32 v[50:51], v[22:23], v[44:45], v[50:51] op_sel:[0,1,0] op_sel_hi:[1,1,1]
v_fmac_f32 v41, v35, v45
v_pk_fma_f32 v[48:49], v[24:25], v[46:47], v[48:49] op_sel_hi:[1,0,1]
v_pk_fma_f32 v[50:51], v[26:27], v[46:47], v[50:51] op_sel_hi:[1,0,1]
v_fmac_f32 v41, v37, v46
v_pk_fma_f32 v[48:49], v[28:29], v[46:47], v[48:49] op_sel:[0,1,0] op_sel_hi:[1,1,1]
v_pk_fma_f32 v[50:51], v[30:31], v[46:47], v[50:51] op_sel:[0,1,0] op_sel_hi:[1,1,1]
v_fmac_f32 v41, v39, v47
v_perm_b32 v52, v48, v51, s60
v_perm_b32 v53, v49, v51, s61
v_perm_b32 v54, v50, v51, s62
v_mov_b32 v55, s36
buffer_store_dwordx4 v[52:55], v8, s[52:55], s68 offen sc1
v_mov_b32 v42, 0
v_mov_b32 v43, 0
v_perm_b32 v56, v40, v43, s60
v_perm_b32 v57, v41, v43, s61
v_perm_b32 v58, v42, v43, s62
v_mov_b32 v59, s36
s_mov_b32 exec_lo, 0x1
s_mov_b32 exec_hi, 0x0
buffer_store_dwordx4 v[56:59], v8, s[52:55], s68 offen offset:1024 sc1
s_mov_b64 exec, -1
s_cmp_eq_u32 s39, 7
s_cbranch_scc1 L_t1
v_and_b32 v9, 7, v0
v_mul_u32_u24 v9, 1152, v9
s_mov_b32 s72, 200000
s_mov_b64 s[84:85], exec
buffer_load_dwordx4 v[48:51], v9, s[52:55], s67 offen offset:1024 sc1
s_add_u32 s69, s67, 0
buffer_load_dwordx4 v[16:19], v8, s[52:55], s69 offen sc1
s_add_u32 s69, s67, 1152
buffer_load_dwordx4 v[20:23], v8, s[52:55], s69 offen sc1
s_add_u32 s69, s67, 2304
buffer_load_dwordx4 v[24:27], v8, s[52:55], s69 offen sc1
s_add_u32 s69, s67, 3456
buffer_load_dwordx4 v[28:31], v8, s[52:55], s69 offen sc1
s_add_u32 s69, s67, 4608
buffer_load_dwordx4 v[32:35], v8, s[52:55], s69 offen sc1
s_add_u32 s69, s67, 5760
buffer_load_dwordx4 v[36:39], v8, s[52:55], s69 offen sc1
s_add_u32 s69, s67, 6912
buffer_load_dwordx4 v[40:43], v8, s[52:55], s69 offen sc1
s_add_u32 s69, s67, 8064
buffer_load_dwordx4 v[44:47], v8, s[52:55], s69 offen sc1
L_ps_44:
s_waitcnt vmcnt(0)
v_cmpx_eq_u32 vcc, s36, v51
v_cmpx_eq_u32 vcc, s36, v19
v_cmpx_eq_u32 vcc, s36, v23
v_cmpx_eq_u32 vcc, s36, v27
v_cmpx_eq_u32 vcc, s36, v31
v_cmpx_eq_u32 vcc, s36, v35
v_cmpx_eq_u32 vcc, s36, v39
v_cmpx_eq_u32 vcc, s36, v43
v_cmpx_eq_u32 vcc, s36, v47
s_cmp_eq_u64 exec, s[84:85]
s_mov_b64 exec, s[84:85]
s_cbranch_scc1 L_psdone_45
s_sub_u32 s72, s72, 1
s_cbranch_scc1 L_psdone_45
v_cmp_ne_u32 vcc, s36, v51
s_cbranch_vccz L_pk_46
buffer_load_dwordx4 v[48:51], v9, s[52:55], s67 offen offset:1024 sc1
L_pk_46:
v_cmp_ne_u32 vcc, s36, v19
s_cbranch_vccz L_pk_47
s_add_u32 s69, s67, 0
buffer_load_dwordx4 v[16:19], v8, s[52:55], s69 offen sc1
L_pk_47:
v_cmp_ne_u32 vcc, s36, v23
s_cbranch_vccz L_pk_48
s_add_u32 s69, s67, 1152
buffer_load_dwordx4 v[20:23], v8, s[52:55], s69 offen sc1
L_pk_48:
v_cmp_ne_u32 vcc, s36, v27
s_cbranch_vccz L_pk_49
s_add_u32 s69, s67, 2304
buffer_load_dwordx4 v[24:27], v8, s[52:55], s69 offen sc1
L_pk_49:
v_cmp_ne_u32 vcc, s36, v31
s_cbranch_vccz L_pk_50
s_add_u32 s69, s67, 3456
buffer_load_dwordx4 v[28:31], v8, s[52:55], s69 offen sc1
L_pk_50:
v_cmp_ne_u32 vcc, s36, v35
s_cbranch_vccz L_pk_51
s_add_u32 s69, s67, 4608
buffer_load_dwordx4 v[32:35], v8, s[52:55], s69 offen sc1
L_pk_51:
v_cmp_ne_u32 vcc, s36, v39
s_cbranch_vccz L_pk_52
s_add_u32 s69, s67, 5760
buffer_load_dwordx4 v[36:39], v8, s[52:55], s69 offen sc1
L_pk_52:
v_cmp_ne_u32 vcc, s36, v43
s_cbranch_vccz L_pk_53
s_add_u32 s69, s67, 6912
buffer_load_dwordx4 v[40:43], v8, s[52:55], s69 offen sc1
L_pk_53:
v_cmp_ne_u32 vcc, s36, v47
s_cbranch_vccz L_pk_54
s_add_u32 s69, s67, 8064
buffer_load_dwordx4 v[44:47], v8, s[52:55], s69 offen sc1
L_pk_54:
s_branch L_ps_44
s_nop 2
L_psdone_45:
v_and_b32 v48, 0xffffff00, v48
v_and_b32 v49, 0xffffff00, v49
v_mov_b32 v50, v48
s_nop 1
v_max_f32_dpp v50, v50, v50 quad_perm:[1,0,3,2] row_mask:0xf bank_mask:0xf
s_nop 1
v_max_f32_dpp v50, v50, v50 quad_perm:[2,3,0,1] row_mask:0xf bank_mask:0xf
s_nop 1
v_max_f32_dpp v50, v50, v50 row_half_mirror row_mask:0xf bank_mask:0xf
v_sub_f32 v48, v48, v50
v_mul_f32 v48, s65, v48
v_exp_f32 v48, v48
v_perm_b32 v19, v16, v17, s63
v_perm_b32 v19, v19, v18, s64
v_perm_b32 v23, v20, v21, s63
v_perm_b32 v23, v23, v22, s64
v_perm_b32 v27, v24, v25, s63
v_perm_b32 v27, v27, v26, s64
v_perm_b32 v31, v28, v29, s63
v_perm_b32 v31, v31, v30, s64
v_perm_b32 v35, v32, v33, s63
v_perm_b32 v35, v35, v34, s64
v_perm_b32 v39, v36, v37, s63
v_perm_b32 v39, v39, v38, s64
v_perm_b32 v43, v40, v41, s63
v_perm_b32 v43, v43, v42, s64
v_perm_b32 v47, v44, v45, s63
v_perm_b32 v47, v47, v46, s64
v_mul_f32 v49, v49, v48
s_nop 1
v_add_f32_dpp v49, v49, v49 quad_perm:[1,0,3,2] row_mask:0xf bank_mask:0xf
s_nop 1
v_add_f32_dpp v49, v49, v49 quad_perm:[2,3,0,1] row_mask:0xf bank_mask:0xf
s_nop 1
v_add_f32_dpp v49, v49, v49 row_half_mirror row_mask:0xf bank_mask:0xf
v_rcp_f32 v49, v49
s_nop 0
v_mul_f32 v48, v48, v49
s_nop 0
v_readlane_b32 s92, v48, 0
v_readlane_b32 s93, v48, 1
v_readlane_b32 s94, v48, 2
v_readlane_b32 s95, v48, 3
v_readlane_b32 s96, v48, 4
v_readlane_b32 s97, v48, 5
v_readlane_b32 s98, v48, 6
v_readlane_b32 s99, v48, 7
v_pk_mul_f32 v[52:53], v[16:17], s[92:93] op_sel_hi:[1,0]
v_pk_mul_f32 v[54:55], v[18:19], s[92:93] op_sel_hi:[1,0]
v_pk_fma_f32 v[52:53], v[20:21], s[92:93], v[52:53] op_sel:[0,1,0] op_sel_hi:[1,1,1]
v_pk_fma_f32 v[54:55], v[22:23], s[92:93], v[54:55] op_sel:[0,1,0] op_sel_hi:[1,1,1]
v_pk_fma_f32 v[52:53], v[24:25], s[94:95], v[52:53] op_sel_hi:[1,0,1]
v_pk_fma_f32 v[54:55], v[26:27], s[94:95], v[54:55] op_sel_hi:[1,0,1]
v_pk_fma_f32 v[52:53], v[28:29], s[94:95], v[52:53] op_sel:[0,1,0] op_sel_hi:[1,1,1]
v_pk_fma_f32 v[54:55], v[30:31], s[94:95], v[54:55] op_sel:[0,1,0] op_sel_hi:[1,1,1]
v_pk_fma_f32 v[52:53], v[32:33], s[96:97], v[52:53] op_sel_hi:[1,0,1]
v_pk_fma_f32 v[54:55], v[34:35], s[96:97], v[54:55] op_sel_hi:[1,0,1]
v_pk_fma_f32 v[52:53], v[36:37], s[96:97], v[52:53] op_sel:[0,1,0] op_sel_hi:[1,1,1]
v_pk_fma_f32 v[54:55], v[38:39], s[96:97], v[54:55] op_sel:[0,1,0] op_sel_hi:[1,1,1]
v_pk_fma_f32 v[52:53], v[40:41], s[98:99], v[52:53] op_sel_hi:[1,0,1]
v_pk_fma_f32 v[54:55], v[42:43], s[98:99], v[54:55] op_sel_hi:[1,0,1]
v_pk_fma_f32 v[52:53], v[44:45], s[98:99], v[52:53] op_sel:[0,1,0] op_sel_hi:[1,1,1]
v_pk_fma_f32 v[54:55], v[46:47], s[98:99], v[54:55] op_sel:[0,1,0] op_sel_hi:[1,1,1]
v_cvt_pk_bf16_f32 v56, v52, v53
v_cvt_pk_bf16_f32 v57, v54, v55
v_lshlrev_b32 v8, 3, v0
ds_write_b64 v8, v[56:57] offset:9472
s_waitcnt lgkmcnt(0)
L_t1:
s_cmp_eq_u32 s39, 7
s_cbranch_scc1 L_end
s_barrier
v_lshlrev_b32 v8, 4, v3
ds_read_b128 v[16:19], v8 offset:9472
ds_read_b128 v[20:23], v8 offset:9536
ds_read_b128 v[24:27], v8 offset:9600
ds_read_b128 v[28:31], v8 offset:9664
ds_read_b128 v[32:35], v8 offset:9728
ds_read_b128 v[36:39], v8 offset:9792
ds_read_b128 v[40:43], v8 offset:9856
ds_read_b128 v[44:47], v8 offset:9920
s_mul_i32 s66, s38, 1792
s_lshl_b32 s67, s39, 8
s_add_u32 s66, s66, s67
s_lshl_b32 s67, s42, 6
s_add_u32 s66, s66, s67
s_add_u32 s66, s66, 557056
s_waitcnt lgkmcnt(0)
v_mfma_f32_16x16x32_bf16 v[48:51], v[64:67], v[16:19], 0
v_mfma_f32_16x16x32_bf16 v[48:51], v[68:71], v[20:23], v[48:51]
v_mfma_f32_16x16x32_bf16 v[48:51], v[72:75], v[24:27], v[48:51]
v_mfma_f32_16x16x32_bf16 v[48:51], v[76:79], v[28:31], v[48:51]
v_mfma_f32_16x16x32_bf16 v[48:51], v[80:83], v[32:35], v[48:51]
v_mfma_f32_16x16x32_bf16 v[48:51], v[84:87], v[36:39], v[48:51]
v_mfma_f32_16x16x32_bf16 v[48:51], v[88:91], v[40:43], v[48:51]
v_mfma_f32_16x16x32_bf16 v[48:51], v[92:95], v[44:47], v[48:51]
s_nop 7
v_perm_b32 v52, v48, v51, s60
v_perm_b32 v53, v49, v51, s61
v_perm_b32 v54, v50, v51, s62
v_mov_b32 v55, s36
s_mov_b32 exec_lo, 0x10001
s_mov_b32 exec_hi, 0x10001
buffer_store_dwordx4 v[52:55], v8, s[52:55], s66 offen sc1
s_mov_b64 exec, -1
s_cmp_eq_u32 s76, 0
s_cbranch_scc1 L_end
s_lshr_b32 s66, s42, 1
s_and_b32 s67, s42, 1
s_mul_i32 s68, s66, 28672
s_mul_i32 s69, s67, 896
s_add_u32 s68, s68, s69
s_add_u32 s68, s68, 557056
v_lshlrev_b32 v8, 4, v0
v_add_u32 v8, s68, v8
s_mov_b32 exec_lo, 0xffffffff
s_mov_b32 exec_hi, 0xffffff
s_mov_b32 s72, 200000
s_mov_b64 s[84:85], exec
s_mov_b32 s70, 0
buffer_load_dwordx4 v[16:19], v8, s[52:55], s70 offen sc1
s_mov_b32 s70, 1792
buffer_load_dwordx4 v[20:23], v8, s[52:55], s70 offen sc1
s_mov_b32 s70, 3584
buffer_load_dwordx4 v[24:27], v8, s[52:55], s70 offen sc1
s_mov_b32 s70, 5376
buffer_load_dwordx4 v[28:31], v8, s[52:55], s70 offen sc1
s_mov_b32 s70, 7168
buffer_load_dwordx4 v[32:35], v8, s[52:55], s70 offen sc1
s_mov_b32 s70, 8960
buffer_load_dwordx4 v[36:39], v8, s[52:55], s70 offen sc1
s_mov_b32 s70, 10752
buffer_load_dwordx4 v[40:43], v8, s[52:55], s70 offen sc1
s_mov_b32 s70, 12544
buffer_load_dwordx4 v[44:47], v8, s[52:55], s70 offen sc1
s_mov_b32 s70, 14336
buffer_load_dwordx4 v[48:51], v8, s[52:55], s70 offen sc1
s_mov_b32 s70, 16128
buffer_load_dwordx4 v[52:55], v8, s[52:55], s70 offen sc1
s_mov_b32 s70, 17920
buffer_load_dwordx4 v[56:59], v8, s[52:55], s70 offen sc1
s_mov_b32 s70, 19712
buffer_load_dwordx4 v[60:63], v8, s[52:55], s70 offen sc1
s_mov_b32 s70, 21504
buffer_load_dwordx4 v[64:67], v8, s[52:55], s70 offen sc1
s_mov_b32 s70, 23296
buffer_load_dwordx4 v[68:71], v8, s[52:55], s70 offen sc1
s_mov_b32 s70, 25088
buffer_load_dwordx4 v[72:75], v8, s[52:55], s70 offen sc1
s_mov_b32 s70, 26880
buffer_load_dwordx4 v[76:79], v8, s[52:55], s70 offen sc1
s_mov_b64 exec, -1
s_mul_i32 s68, s66, 1792
s_mul_i32 s69, s67, 896
s_add_u32 s68, s68, s69
v_lshlrev_b32 v204, 4, v0
v_add_u32 v204, s68, v204
s_lshl_b32 s68, s42, 3
v_mov_b32 v205, s68
s_lshl_b32 s68, s66, 4
v_mov_b32 v206, s68
s_mul_i32 s68, s66, 896
s_mul_i32 s69, s67, 448
s_add_u32 s68, s68, s69
v_lshlrev_b32 v207, 3, v0
v_add_u32 v207, s68, v207
v_subrev_u32 v208, s89, v4
v_and_b32 v210, 1, v2
v_lshlrev_b32 v210, 6, v210
v_and_b32 v209, 1, v3
v_lshlrev_b32 v209, 3, v209
s_lshl_b32 s68, s42, 4
v_add3_u32 v209, v210, v209, s68
v_lshlrev_b32 v211, 4, v3
v_add_u32 v210, v210, v211
v_mul_u32_u24 v9, 1792, v2
v_add_u32 v211, v9, v211
s_mul_i32 s88, s77, 3584
s_mul_i32 s68, s42, 448
s_add_u32 s88, s88, s68
s_add_u32 s88, s88, 614400
v_mov_b32 v215, s36
v_mov_b32 v219, s36
v_mov_b32 v223, s36
v_mov_b32 v227, s36
v_mov_b32 v231, s36
v_mov_b32 v235, s36
v_mov_b32 v239, s36
s_mov_b32 s56, 0xffffffff
s_mov_b32 s57, 0xffffff
s_mov_b64 exec, s[84:85]
L_ps_55:
s_waitcnt vmcnt(0)
v_cmpx_eq_u32 vcc, s36, v19
v_cmpx_eq_u32 vcc, s36, v23
v_cmpx_eq_u32 vcc, s36, v27
v_cmpx_eq_u32 vcc, s36, v31
v_cmpx_eq_u32 vcc, s36, v35
v_cmpx_eq_u32 vcc, s36, v39
v_cmpx_eq_u32 vcc, s36, v43
v_cmpx_eq_u32 vcc, s36, v47
v_cmpx_eq_u32 vcc, s36, v51
v_cmpx_eq_u32 vcc, s36, v55
v_cmpx_eq_u32 vcc, s36, v59
v_cmpx_eq_u32 vcc, s36, v63
v_cmpx_eq_u32 vcc, s36, v67
v_cmpx_eq_u32 vcc, s36, v71
v_cmpx_eq_u32 vcc, s36, v75
v_cmpx_eq_u32 vcc, s36, v79
s_cmp_eq_u64 exec, s[84:85]
s_mov_b64 exec, s[84:85]
s_cbranch_scc1 L_psdone_56
s_sub_u32 s72, s72, 1
s_cbranch_scc1 L_psdone_56
v_cmp_ne_u32 vcc, s36, v19
s_cbranch_vccz L_pk_57
s_mov_b32 s70, 0
buffer_load_dwordx4 v[16:19], v8, s[52:55], s70 offen sc1
L_pk_57:
v_cmp_ne_u32 vcc, s36, v23
s_cbranch_vccz L_pk_58
s_mov_b32 s70, 1792
buffer_load_dwordx4 v[20:23], v8, s[52:55], s70 offen sc1
L_pk_58:
v_cmp_ne_u32 vcc, s36, v27
s_cbranch_vccz L_pk_59
s_mov_b32 s70, 3584
buffer_load_dwordx4 v[24:27], v8, s[52:55], s70 offen sc1
L_pk_59:
v_cmp_ne_u32 vcc, s36, v31
s_cbranch_vccz L_pk_60
s_mov_b32 s70, 5376
buffer_load_dwordx4 v[28:31], v8, s[52:55], s70 offen sc1
L_pk_60:
v_cmp_ne_u32 vcc, s36, v35
s_cbranch_vccz L_pk_61
s_mov_b32 s70, 7168
buffer_load_dwordx4 v[32:35], v8, s[52:55], s70 offen sc1
L_pk_61:
v_cmp_ne_u32 vcc, s36, v39
s_cbranch_vccz L_pk_62
s_mov_b32 s70, 8960
buffer_load_dwordx4 v[36:39], v8, s[52:55], s70 offen sc1
L_pk_62:
v_cmp_ne_u32 vcc, s36, v43
s_cbranch_vccz L_pk_63
s_mov_b32 s70, 10752
buffer_load_dwordx4 v[40:43], v8, s[52:55], s70 offen sc1
L_pk_63:
v_cmp_ne_u32 vcc, s36, v47
s_cbranch_vccz L_pk_64
s_mov_b32 s70, 12544
buffer_load_dwordx4 v[44:47], v8, s[52:55], s70 offen sc1
L_pk_64:
v_cmp_ne_u32 vcc, s36, v51
s_cbranch_vccz L_pk_65
s_mov_b32 s70, 14336
buffer_load_dwordx4 v[48:51], v8, s[52:55], s70 offen sc1
L_pk_65:
v_cmp_ne_u32 vcc, s36, v55
s_cbranch_vccz L_pk_66
s_mov_b32 s70, 16128
buffer_load_dwordx4 v[52:55], v8, s[52:55], s70 offen sc1
L_pk_66:
v_cmp_ne_u32 vcc, s36, v59
s_cbranch_vccz L_pk_67
s_mov_b32 s70, 17920
buffer_load_dwordx4 v[56:59], v8, s[52:55], s70 offen sc1
L_pk_67:
v_cmp_ne_u32 vcc, s36, v63
s_cbranch_vccz L_pk_68
s_mov_b32 s70, 19712
buffer_load_dwordx4 v[60:63], v8, s[52:55], s70 offen sc1
L_pk_68:
v_cmp_ne_u32 vcc, s36, v67
s_cbranch_vccz L_pk_69
s_mov_b32 s70, 21504
buffer_load_dwordx4 v[64:67], v8, s[52:55], s70 offen sc1
L_pk_69:
v_cmp_ne_u32 vcc, s36, v71
s_cbranch_vccz L_pk_70
s_mov_b32 s70, 23296
buffer_load_dwordx4 v[68:71], v8, s[52:55], s70 offen sc1
L_pk_70:
v_cmp_ne_u32 vcc, s36, v75
s_cbranch_vccz L_pk_71
s_mov_b32 s70, 25088
buffer_load_dwordx4 v[72:75], v8, s[52:55], s70 offen sc1
L_pk_71:
v_cmp_ne_u32 vcc, s36, v79
s_cbranch_vccz L_pk_72
s_mov_b32 s70, 26880
buffer_load_dwordx4 v[76:79], v8, s[52:55], s70 offen sc1
L_pk_72:
s_branch L_ps_55
s_nop 2
L_psdone_56:
v_perm_b32 v19, v16, v17, s63
v_perm_b32 v19, v19, v18, s64
v_perm_b32 v23, v20, v21, s63
v_perm_b32 v23, v23, v22, s64
v_perm_b32 v27, v24, v25, s63
v_perm_b32 v27, v27, v26, s64
v_perm_b32 v31, v28, v29, s63
v_perm_b32 v31, v31, v30, s64
v_perm_b32 v35, v32, v33, s63
v_perm_b32 v35, v35, v34, s64
v_perm_b32 v39, v36, v37, s63
v_perm_b32 v39, v39, v38, s64
v_perm_b32 v43, v40, v41, s63
v_perm_b32 v43, v43, v42, s64
v_perm_b32 v47, v44, v45, s63
v_perm_b32 v47, v47, v46, s64
v_perm_b32 v51, v48, v49, s63
v_perm_b32 v51, v51, v50, s64
v_perm_b32 v55, v52, v53, s63
v_perm_b32 v55, v55, v54, s64
v_perm_b32 v59, v56, v57, s63
v_perm_b32 v59, v59, v58, s64
v_perm_b32 v63, v60, v61, s63
v_perm_b32 v63, v63, v62, s64
v_perm_b32 v67, v64, v65, s63
v_perm_b32 v67, v67, v66, s64
v_perm_b32 v71, v68, v69, s63
v_perm_b32 v71, v71, v70, s64
v_perm_b32 v75, v72, v73, s63
v_perm_b32 v75, v75, v74, s64
v_perm_b32 v79, v76, v77, s63
v_perm_b32 v79, v79, v78, s64
v_pk_add_f32 v[16:17], v[16:17], v[48:49]
v_pk_add_f32 v[18:19], v[18:19], v[50:51]
v_pk_add_f32 v[20:21], v[20:21], v[52:53]
v_pk_add_f32 v[22:23], v[22:23], v[54:55]
v_pk_add_f32 v[24:25], v[24:25], v[56:57]
v_pk_add_f32 v[26:27], v[26:27], v[58:59]
v_pk_add_f32 v[28:29], v[28:29], v[60:61]
v_pk_add_f32 v[30:31], v[30:31], v[62:63]
v_pk_add_f32 v[32:33], v[32:33], v[64:65]
v_pk_add_f32 v[34:35], v[34:35], v[66:67]
v_pk_add_f32 v[36:37], v[36:37], v[68:69]
v_pk_add_f32 v[38:39], v[38:39], v[70:71]
v_pk_add_f32 v[40:41], v[40:41], v[72:73]
v_pk_add_f32 v[42:43], v[42:43], v[74:75]
v_pk_add_f32 v[44:45], v[44:45], v[76:77]
v_pk_add_f32 v[46:47], v[46:47], v[78:79]
v_pk_add_f32 v[16:17], v[16:17], v[32:33]
v_pk_add_f32 v[18:19], v[18:19], v[34:35]
v_pk_add_f32 v[20:21], v[20:21], v[36:37]
v_pk_add_f32 v[22:23], v[22:23], v[38:39]
v_pk_add_f32 v[24:25], v[24:25], v[40:41]
v_pk_add_f32 v[26:27], v[26:27], v[42:43]
v_pk_add_f32 v[28:29], v[28:29], v[44:45]
v_pk_add_f32 v[30:31], v[30:31], v[46:47]
v_pk_add_f32 v[16:17], v[16:17], v[24:25]
v_pk_add_f32 v[18:19], v[18:19], v[26:27]
v_pk_add_f32 v[20:21], v[20:21], v[28:29]
v_pk_add_f32 v[22:23], v[22:23], v[30:31]
v_pk_add_f32 v[16:17], v[16:17], v[20:21]
v_pk_add_f32 v[18:19], v[18:19], v[22:23]
v_cvt_pk_bf16_f32 v20, v16, v17
v_lshlrev_b32 v16, 16, v20
v_and_b32 v17, 0xffff0000, v20
v_cvt_pk_bf16_f32 v20, v18, v19
v_lshlrev_b32 v18, 16, v20
v_and_b32 v19, 0xffff0000, v20
v_pk_mul_f32 v[16:17], v[16:17], v[192:193]
v_pk_mul_f32 v[18:19], v[18:19], v[194:195]
v_cvt_pk_bf16_f32 v20, v16, v17
v_lshlrev_b32 v16, 16, v20
v_and_b32 v17, 0xffff0000, v20
v_cvt_pk_bf16_f32 v20, v18, v19
v_lshlrev_b32 v18, 16, v20
v_and_b32 v19, 0xffff0000, v20
v_pk_add_f32 v[16:17], v[16:17], v[196:197]
v_pk_add_f32 v[18:19], v[18:19], v[198:199]
v_cvt_pk_bf16_f32 v20, v16, v17
v_lshlrev_b32 v16, 16, v20
v_and_b32 v17, 0xffff0000, v20
v_cvt_pk_bf16_f32 v20, v18, v19
v_lshlrev_b32 v18, 16, v20
v_and_b32 v19, 0xffff0000, v20
ds_write_b128 v204, v[16:19] offset:14304
v_add_f32 v24, v16, v17
v_mul_f32 v25, v16, v16
v_add_f32 v26, v18, v19
v_fmac_f32 v25, v17, v17
v_add_f32 v24, v24, v26
v_fmac_f32 v25, v18, v18
v_fmac_f32 v25, v19, v19
s_mov_b64 exec, -1
v_cndmask_b32 v24, 0, v24, s[56:57]
v_cndmask_b32 v25, 0, v25, s[56:57]
s_nop 0
v_add_f32_dpp v24, v24, v24 quad_perm:[1,0,3,2] row_mask:0xf bank_mask:0xf
v_add_f32_dpp v25, v25, v25 quad_perm:[1,0,3,2] row_mask:0xf bank_mask:0xf
s_nop 0
v_add_f32_dpp v24, v24, v24 quad_perm:[2,3,0,1] row_mask:0xf bank_mask:0xf
v_add_f32_dpp v25, v25, v25 quad_perm:[2,3,0,1] row_mask:0xf bank_mask:0xf
s_nop 0
v_add_f32_dpp v24, v24, v24 row_half_mirror row_mask:0xf bank_mask:0xf
v_add_f32_dpp v25, v25, v25 row_half_mirror row_mask:0xf bank_mask:0xf
s_nop 0
v_add_f32_dpp v24, v24, v24 row_mirror row_mask:0xf bank_mask:0xf
v_add_f32_dpp v25, v25, v25 row_mirror row_mask:0xf bank_mask:0xf
v_mov_b32 v26, v24
v_mov_b32 v27, v25
s_nop 0
v_permlane16_swap_b32 v24, v26
v_permlane16_swap_b32 v25, v27
v_add_f32 v24, v24, v26
v_add_f32 v25, v25, v27
v_mov_b32 v26, v24
v_mov_b32 v27, v25
s_nop 0
v_permlane32_swap_b32 v24, v26
v_permlane32_swap_b32 v25, v27
v_add_f32 v24, v24, v26
v_add_f32 v25, v25, v27
ds_write_b64 v205, v[24:25] offset:14144
s_waitcnt lgkmcnt(0)
s_barrier
ds_read_b128 v[24:27], v206 offset:14144
s_waitcnt lgkmcnt(0)
v_pk_add_f32 v[24:25], v[24:25], v[26:27]
v_mul_f32 v24, 0x3b124925, v24
v_mul_f32 v25, 0x3b124925, v25
v_fma_f32 v25, -v24, v24, v25
v_max_f32 v25, 0, v25
v_cvt_pk_bf16_f32 v26, v24, v25
v_lshlrev_b32 v24, 16, v26
v_and_b32 v25, 0xffff0000, v26
v_add_f32 v25, 0x3727c5ac, v25
v_cvt_pk_bf16_f32 v26, v25, v25
v_lshlrev_b32 v25, 16, v26
v_sqrt_f32 v25, v25
s_nop 0
v_cvt_pk_bf16_f32 v26, v25, v25
v_lshlrev_b32 v25, 16, v26
v_rcp_f32 v25, v25
s_nop 0
v_pk_add_f32 v[28:29], v[16:17], v[24:25] op_sel_hi:[1,0] neg_lo:[0,1] neg_hi:[0,1]
v_pk_add_f32 v[30:31], v[18:19], v[24:25] op_sel_hi:[1,0] neg_lo:[0,1] neg_hi:[0,1]
v_cvt_pk_bf16_f32 v26, v28, v29
v_lshlrev_b32 v28, 16, v26
v_and_b32 v29, 0xffff0000, v26
v_cvt_pk_bf16_f32 v26, v30, v31
v_lshlrev_b32 v30, 16, v26
v_and_b32 v31, 0xffff0000, v26
v_pk_mul_f32 v[28:29], v[28:29], v[24:25] op_sel:[0,1] op_sel_hi:[1,1]
v_pk_mul_f32 v[30:31], v[30:31], v[24:25] op_sel:[0,1] op_sel_hi:[1,1]
v_cvt_pk_bf16_f32 v26, v28, v29
v_lshlrev_b32 v28, 16, v26
v_and_b32 v29, 0xffff0000, v26
v_cvt_pk_bf16_f32 v26, v30, v31
v_lshlrev_b32 v30, 16, v26
v_and_b32 v31, 0xffff0000, v26
v_pk_mul_f32 v[28:29], v[28:29], v[184:185]
v_pk_mul_f32 v[30:31], v[30:31], v[186:187]
v_cvt_pk_bf16_f32 v26, v28, v29
v_lshlrev_b32 v28, 16, v26
v_and_b32 v29, 0xffff0000, v26
v_cvt_pk_bf16_f32 v26, v30, v31
v_lshlrev_b32 v30, 16, v26
v_and_b32 v31, 0xffff0000, v26
v_pk_add_f32 v[28:29], v[28:29], v[188:189]
v_pk_add_f32 v[30:31], v[30:31], v[190:191]
v_cvt_pk_bf16_f32 v28, v28, v29
v_cvt_pk_bf16_f32 v29, v30, v31
s_mov_b64 exec, s[56:57]
ds_write_b64 v207, v[28:29] offset:0
s_mov_b64 exec, -1
s_waitcnt lgkmcnt(0)
s_barrier
ds_read_b128 v[8:11], v208 offset:0
ds_read_b128 v[12:15], v208 offset:64
ds_read_b128 v[16:19], v208 offset:128
ds_read_b128 v[20:23], v208 offset:192
ds_read_b128 v[24:27], v208 offset:256
ds_read_b128 v[28:31], v208 offset:320
ds_read_b128 v[32:35], v208 offset:384
ds_read_b128 v[36:39], v208 offset:448
ds_read_b128 v[40:43], v208 offset:512
ds_read_b128 v[44:47], v208 offset:576
ds_read_b128 v[48:51], v208 offset:640
ds_read_b128 v[52:55], v208 offset:704
ds_read_b128 v[56:59], v208 offset:768
ds_read_b128 v[60:63], v208 offset:832
s_waitcnt lgkmcnt(13)
v_mfma_f32_16x16x32_bf16 v[64:67], v[96:99], v[8:11], 0
s_waitcnt lgkmcnt(12)
v_mfma_f32_16x16x32_bf16 v[64:67], v[100:103], v[12:15], v[64:67]
s_waitcnt lgkmcnt(11)
v_mfma_f32_16x16x32_bf16 v[64:67], v[104:107], v[16:19], v[64:67]
s_waitcnt lgkmcnt(10)
v_mfma_f32_16x16x32_bf16 v[64:67], v[108:111], v[20:23], v[64:67]
s_waitcnt lgkmcnt(9)
v_mfma_f32_16x16x32_bf16 v[64:67], v[112:115], v[24:27], v[64:67]
s_waitcnt lgkmcnt(8)
v_mfma_f32_16x16x32_bf16 v[64:67], v[116:119], v[28:31], v[64:67]
s_waitcnt lgkmcnt(7)
v_mfma_f32_16x16x32_bf16 v[64:67], v[120:123], v[32:35], v[64:67]
s_waitcnt lgkmcnt(6)
v_mfma_f32_16x16x32_bf16 v[64:67], v[124:127], v[36:39], v[64:67]
s_waitcnt lgkmcnt(5)
v_mfma_f32_16x16x32_bf16 v[64:67], v[128:131], v[40:43], v[64:67]
s_waitcnt lgkmcnt(4)
v_mfma_f32_16x16x32_bf16 v[64:67], v[132:135], v[44:47], v[64:67]
s_waitcnt lgkmcnt(3)
v_mfma_f32_16x16x32_bf16 v[64:67], v[136:139], v[48:51], v[64:67]
s_waitcnt lgkmcnt(2)
v_mfma_f32_16x16x32_bf16 v[64:67], v[140:143], v[52:55], v[64:67]
s_waitcnt lgkmcnt(1)
v_mfma_f32_16x16x32_bf16 v[64:67], v[144:147], v[56:59], v[64:67]
s_waitcnt lgkmcnt(0)
v_mfma_f32_16x16x32_bf16 v[64:67], v[148:151], v[60:63], v[64:67]
s_nop 7
v_cvt_pk_bf16_f32 v8, v64, v65
v_lshlrev_b32 v64, 16, v8
v_and_b32 v65, 0xffff0000, v8
v_cvt_pk_bf16_f32 v8, v66, v67
v_lshlrev_b32 v66, 16, v8
v_and_b32 v67, 0xffff0000, v8
v_mov_b32 v68, v64
v_mov_b32 v69, v65
v_mov_b32 v70, v66
v_mov_b32 v71, v67
v_permlane32_swap_b32 v64, v68
v_permlane32_swap_b32 v65, v69
v_permlane32_swap_b32 v66, v70
v_permlane32_swap_b32 v67, v71
v_mul_f32 v72, 0xbfb8aa3b, v64
v_mul_f32 v73, 0xbfb8aa3b, v65
v_mul_f32 v74, 0xbfb8aa3b, v66
v_mul_f32 v75, 0xbfb8aa3b, v67
v_exp_f32 v72, v72
v_exp_f32 v73, v73
v_exp_f32 v74, v74
v_exp_f32 v75, v75
v_add_f32 v72, 1.0, v72
v_add_f32 v73, 1.0, v73
v_add_f32 v74, 1.0, v74
v_add_f32 v75, 1.0, v75
v_rcp_f32 v72, v72
v_rcp_f32 v73, v73
v_rcp_f32 v74, v74
v_rcp_f32 v75, v75
v_cvt_pk_bf16_f32 v8, v72, v73
v_lshlrev_b32 v72, 16, v8
v_and_b32 v73, 0xffff0000, v8
v_cvt_pk_bf16_f32 v8, v74, v75
v_lshlrev_b32 v74, 16, v8
v_and_b32 v75, 0xffff0000, v8
v_pk_mul_f32 v[72:73], v[72:73], v[68:69]
v_pk_mul_f32 v[74:75], v[74:75], v[70:71]
v_cvt_pk_bf16_f32 v76, v72, v73
v_cvt_pk_bf16_f32 v77, v74, v75
s_mov_b32 exec_lo, 0x30003
s_mov_b32 exec_hi, 0x0
ds_write_b64 v209, v[76:77] offset:14176
s_mov_b64 exec, -1
s_waitcnt lgkmcnt(0)
s_barrier
ds_read_b128 v[12:15], v210 offset:14176
s_waitcnt lgkmcnt(0)
v_mfma_f32_16x16x32_bf16 v[16:19], v[152:155], v[12:15], 0
v_mfma_f32_16x16x32_bf16 v[20:23], v[156:159], v[12:15], 0
v_mfma_f32_16x16x32_bf16 v[24:27], v[160:163], v[12:15], 0
v_mfma_f32_16x16x32_bf16 v[28:31], v[164:167], v[12:15], 0
v_mfma_f32_16x16x32_bf16 v[32:35], v[168:171], v[12:15], 0
v_mfma_f32_16x16x32_bf16 v[36:39], v[172:175], v[12:15], 0
v_mfma_f32_16x16x32_bf16 v[40:43], v[176:179], v[12:15], 0
s_mov_b32 exec_lo, 0x30003
s_mov_b32 exec_hi, 0x30003
v_perm_b32 v212, v16, v19, s60
v_perm_b32 v213, v17, v19, s61
v_perm_b32 v214, v18, v19, s62
buffer_store_dwordx4 v[212:215], v211, s[52:55], s88 offen offset:0 sc1
v_perm_b32 v216, v20, v23, s60
v_perm_b32 v217, v21, v23, s61
v_perm_b32 v218, v22, v23, s62
buffer_store_dwordx4 v[216:219], v211, s[52:55], s88 offen offset:64 sc1
v_perm_b32 v220, v24, v27, s60
v_perm_b32 v221, v25, v27, s61
v_perm_b32 v222, v26, v27, s62
buffer_store_dwordx4 v[220:223], v211, s[52:55], s88 offen offset:128 sc1
v_perm_b32 v224, v28, v31, s60
v_perm_b32 v225, v29, v31, s61
v_perm_b32 v226, v30, v31, s62
buffer_store_dwordx4 v[224:227], v211, s[52:55], s88 offen offset:192 sc1
v_perm_b32 v228, v32, v35, s60
v_perm_b32 v229, v33, v35, s61
v_perm_b32 v230, v34, v35, s62
buffer_store_dwordx4 v[228:231], v211, s[52:55], s88 offen offset:256 sc1
v_perm_b32 v232, v36, v39, s60
v_perm_b32 v233, v37, v39, s61
v_perm_b32 v234, v38, v39, s62
buffer_store_dwordx4 v[232:235], v211, s[52:55], s88 offen offset:320 sc1
v_perm_b32 v236, v40, v43, s60
v_perm_b32 v237, v41, v43, s61
v_perm_b32 v238, v42, v43, s62
buffer_store_dwordx4 v[236:239], v211, s[52:55], s88 offen offset:384 sc1
s_mov_b64 exec, -1
s_cmp_lt_u32 s76, 2
s_cbranch_scc1 L_end
s_cmp_lg_u32 s42, 0
s_cbranch_scc1 L_end
v_lshrrev_b32 v8, 3, v0
v_mul_u32_u24 v8, 3584, v8
v_bfe_u32 v9, v0, 2, 1
v_mul_u32_u24 v10, 1792, v9
v_and_b32 v11, 3, v0
v_lshlrev_b32 v11, 4, v11
v_add3_u32 v8, v8, v10, v11
s_lshl_b32 s66, s77, 6
s_add_u32 s66, s66, 614400
v_add_u32 v8, s66, v8
s_lshl_b32 s67, s77, 6
v_add3_u32 v12, v10, v11, s67
ds_read_b128 v[48:51], v12 offset:14304
v_mul_u32_u24 v10, 896, v9
v_lshrrev_b32 v11, 1, v11
s_lshl_b32 s66, s77, 5
v_add3_u32 v10, v10, v11, s66
s_mov_b32 s44, s30
s_mov_b32 s45, s31
s_mov_b32 s46, 1792
s_mov_b32 s47, 0x20000
s_mov_b32 s72, 200000
s_mov_b64 s[84:85], exec
s_mov_b32 s70, 0
buffer_load_dwordx4 v[16:19], v8, s[52:55], s70 offen sc1
s_mov_b32 s70, 28672
buffer_load_dwordx4 v[20:23], v8, s[52:55], s70 offen sc1
s_mov_b32 s70, 57344
buffer_load_dwordx4 v[24:27], v8, s[52:55], s70 offen sc1
s_mov_b32 s70, 86016
buffer_load_dwordx4 v[28:31], v8, s[52:55], s70 offen sc1
s_mov_b32 s70, 114688
buffer_load_dwordx4 v[32:35], v8, s[52:55], s70 offen sc1
s_mov_b32 s70, 143360
buffer_load_dwordx4 v[36:39], v8, s[52:55], s70 offen sc1
s_mov_b32 s70, 172032
buffer_load_dwordx4 v[40:43], v8, s[52:55], s70 offen sc1
L_pp_73:
s_waitcnt vmcnt(0)
v_cmpx_eq_u32 vcc, s36, v19
v_cmpx_eq_u32 vcc, s36, v23
v_cmpx_eq_u32 vcc, s36, v27
v_cmpx_eq_u32 vcc, s36, v31
v_cmpx_eq_u32 vcc, s36, v35
v_cmpx_eq_u32 vcc, s36, v39
v_cmpx_eq_u32 vcc, s36, v43
s_cmp_eq_u64 exec, s[84:85]
s_mov_b64 exec, s[84:85]
s_nop 1
s_cbranch_scc1 L_ppok_75
s_mov_b32 s70, 0
buffer_load_dwordx4 v[16:19], v8, s[52:55], s70 offen sc1
s_mov_b32 s70, 28672
buffer_load_dwordx4 v[20:23], v8, s[52:55], s70 offen sc1
s_mov_b32 s70, 57344
buffer_load_dwordx4 v[24:27], v8, s[52:55], s70 offen sc1
s_mov_b32 s70, 86016
buffer_load_dwordx4 v[28:31], v8, s[52:55], s70 offen sc1
s_mov_b32 s70, 114688
buffer_load_dwordx4 v[32:35], v8, s[52:55], s70 offen sc1
s_mov_b32 s70, 143360
buffer_load_dwordx4 v[36:39], v8, s[52:55], s70 offen sc1
s_mov_b32 s70, 172032
buffer_load_dwordx4 v[40:43], v8, s[52:55], s70 offen sc1
s_sub_u32 s72, s72, 1
s_cbranch_scc0 L_pp_73
L_ppok_75:
v_perm_b32 v19, v16, v17, s63
v_perm_b32 v19, v19, v18, s64
v_perm_b32 v23, v20, v21, s63
v_perm_b32 v23, v23, v22, s64
v_perm_b32 v27, v24, v25, s63
v_perm_b32 v27, v27, v26, s64
v_perm_b32 v31, v28, v29, s63
v_perm_b32 v31, v31, v30, s64
v_perm_b32 v35, v32, v33, s63
v_perm_b32 v35, v35, v34, s64
v_perm_b32 v39, v36, v37, s63
v_perm_b32 v39, v39, v38, s64
v_perm_b32 v43, v40, v41, s63
v_perm_b32 v43, v43, v42, s64
v_pk_add_f32 v[16:17], v[16:17], v[20:21]
v_pk_add_f32 v[18:19], v[18:19], v[22:23]
v_pk_add_f32 v[24:25], v[24:25], v[28:29]
v_pk_add_f32 v[26:27], v[26:27], v[30:31]
v_pk_add_f32 v[32:33], v[32:33], v[36:37]
v_pk_add_f32 v[34:35], v[34:35], v[38:39]
v_pk_add_f32 v[16:17], v[16:17], v[24:25]
v_pk_add_f32 v[18:19], v[18:19], v[26:27]
v_pk_add_f32 v[32:33], v[32:33], v[40:41]
v_pk_add_f32 v[34:35], v[34:35], v[42:43]
v_pk_add_f32 v[44:45], v[16:17], v[32:33]
v_pk_add_f32 v[46:47], v[18:19], v[34:35]
s_nop 1
L_ppdone_74:
v_add_f32_dpp v44, v44, v44 row_ror:8 row_mask:0xf bank_mask:0xf
v_add_f32_dpp v45, v45, v45 row_ror:8 row_mask:0xf bank_mask:0xf
v_add_f32_dpp v46, v46, v46 row_ror:8 row_mask:0xf bank_mask:0xf
v_add_f32_dpp v47, v47, v47 row_ror:8 row_mask:0xf bank_mask:0xf
v_mov_b32 v52, v44
v_mov_b32 v53, v45
v_mov_b32 v54, v46
v_mov_b32 v55, v47
v_permlane16_swap_b32 v44, v52
v_permlane16_swap_b32 v45, v53
v_permlane16_swap_b32 v46, v54
v_permlane16_swap_b32 v47, v55
v_add_f32 v44, v44, v52
v_add_f32 v45, v45, v53
v_add_f32 v46, v46, v54
v_add_f32 v47, v47, v55
v_mov_b32 v52, v44
v_mov_b32 v53, v45
v_mov_b32 v54, v46
v_mov_b32 v55, v47
v_permlane32_swap_b32 v44, v52
v_permlane32_swap_b32 v45, v53
v_permlane32_swap_b32 v46, v54
v_permlane32_swap_b32 v47, v55
v_add_f32 v44, v44, v52
v_add_f32 v45, v45, v53
v_add_f32 v46, v46, v54
v_add_f32 v47, v47, v55
v_cvt_pk_bf16_f32 v52, v44, v45
v_lshlrev_b32 v44, 16, v52
v_and_b32 v45, 0xffff0000, v52
v_cvt_pk_bf16_f32 v52, v46, v47
v_lshlrev_b32 v46, 16, v52
v_and_b32 v47, 0xffff0000, v52
v_pk_mul_f32 v[44:45], v[44:45], v[200:201]
v_pk_mul_f32 v[46:47], v[46:47], v[202:203]
v_cvt_pk_bf16_f32 v52, v44, v45
v_lshlrev_b32 v44, 16, v52
v_and_b32 v45, 0xffff0000, v52
v_cvt_pk_bf16_f32 v52, v46, v47
v_lshlrev_b32 v46, 16, v52
v_and_b32 v47, 0xffff0000, v52
s_waitcnt lgkmcnt(0)
v_pk_add_f32 v[44:45], v[44:45], v[48:49]
v_pk_add_f32 v[46:47], v[46:47], v[50:51]
v_cvt_pk_bf16_f32 v56, v44, v45
v_cvt_pk_bf16_f32 v57, v46, v47
s_mov_b32 exec_lo, 0xff
s_mov_b32 exec_hi, 0x0
buffer_store_dwordx2 v[56:57], v10, s[44:47], 0 offen
s_cmp_lg_u32 s77, 0
s_cbranch_scc1 L_fin
s_mov_b32 exec_lo, 0x1
s_mov_b32 exec_hi, 0x0
v_mov_b32 v8, 0
v_mov_b32 v9, s36
buffer_store_dword v9, v8, s[52:55], 0 offen sc1
s_nop 0
L_fin:
s_mov_b64 exec, -1
L_end:
s_endpgm
.section .rodata,"a"
.p2align 6
.amdhsa_kernel adaLN_cond__mha_block_cached__glu_gated_glu__decode_kernel
  .amdhsa_next_free_vgpr 256
  .amdhsa_next_free_sgpr 102
  .amdhsa_accum_offset 256
  .amdhsa_group_segment_fixed_size 0
  .amdhsa_kernarg_size 112
  .amdhsa_user_sgpr_count 2
  .amdhsa_user_sgpr_kernarg_segment_ptr 1
  .amdhsa_system_sgpr_workgroup_id_x 1
.end_amdhsa_kernel
```
